```python
import torch

def _softmax(x, axis=-1):
    return torch.softmax(x, dim=axis)
def _gelu(x):
    return torch.nn.functional.gelu(x, approximate="tanh")
def _silu(x):
    return torch.nn.functional.silu(x)
def _sigmoid(x):
    return torch.sigmoid(x)
def _layernorm(x, axis=-1, eps=1e-5):
    m = x.mean(dim=axis, keepdim=True)
    v = x.var(dim=axis, keepdim=True, unbiased=False)
    return (x - m) / torch.sqrt(v + eps)
def _scatter_add(tgt, idx, src, axis=0):
    return tgt.clone().index_add_(axis, idx, src)
def _segment_sum(src, seg, n):
    out = torch.zeros((n,) + src.shape[1:], dtype=src.dtype)
    return out.index_add_(0, seg, src)
def _pad(x, pw):
    flat = tuple(v for pair in reversed(pw) for v in pair)
    return torch.nn.functional.pad(x, flat)

kernel_name = 'concat_heads__mha_block_cached__gqa_block_cached__near_ridge'

def setup_inputs():

    _w = (lambda a: (lambda t: t.to(torch.bfloat16) if t.is_floating_point() else t)(torch.as_tensor(a)))
    def _A_setup():
        B, Sq, D = 8, 128, 512
        H, Sk, Dh = 32, 512, 128
        return {
            "x": _w((lambda *s: torch.randn(*s, dtype=torch.bfloat16) * 0.8)(B, Sq, D)),
            "k_cache": _w((lambda *s: torch.randn(*s, dtype=torch.bfloat16) * 0.8)(B, H, Sk, Dh)),
            "v_cache": _w((lambda *s: torch.randn(*s, dtype=torch.bfloat16) * 0.05)(B, H, Sk, Dh)),
            "wq": _w((lambda *s: torch.randn(*s, dtype=torch.bfloat16) * 0.8)(D, H * Dh) * (D ** -0.5)),
            "wo": _w((lambda *s: torch.randn(*s, dtype=torch.bfloat16) * 0.05)(H * Dh, D) * ((H * Dh) ** -0.5)),
        }
    _A_in = _A_setup()

    def _B_setup():
        B, Sq, D = 8, 128, 512
        Hq, Hkv, Sk, Dh = 32, 32, 512, 128
        assert Hq % Hkv == 0, (Hq, Hkv)
        return {
            "x": _w((lambda *s: torch.randn(*s, dtype=torch.bfloat16) * 0.8)(B, Sq, D)),
            "k_cache": _w((lambda *s: torch.randn(*s, dtype=torch.bfloat16) * 0.8)(B, Hkv, Sk, Dh)),
            "v_cache": _w((lambda *s: torch.randn(*s, dtype=torch.bfloat16) * 0.05)(B, Hkv, Sk, Dh)),
            "wq": _w((lambda *s: torch.randn(*s, dtype=torch.bfloat16) * 0.8)(D, Hq * Dh) * (D ** -0.5)),
            "wo": _w((lambda *s: torch.randn(*s, dtype=torch.bfloat16) * 0.05)(Hq * Dh, D) * ((Hq * Dh) ** -0.5)),
        }
    _B_in = _B_setup()

    return {
        "A_x": _A_in["x"],
        "A_k_cache": _A_in["k_cache"],
        "A_v_cache": _A_in["v_cache"],
        "A_wq": _A_in["wq"],
        "A_wo": _A_in["wo"],
        "B_x": _B_in["x"],
        "B_k_cache": _B_in["k_cache"],
        "B_v_cache": _B_in["v_cache"],
        "B_wq": _B_in["wq"],
        "B_wo": _B_in["wo"],
    }

def reference(A_x, A_k_cache, A_v_cache, A_wq, A_wo, B_x, B_k_cache, B_v_cache, B_wq, B_wo):
    def _A_ref(x, k_cache, v_cache, wq, wo):
        B, Sq, D = x.shape
        H, Dh = 32, 128
        q = (lambda x, *d: x.permute(*d))((x @ wq).reshape(B, Sq, H, Dh), 0, 2, 1, 3)
        scores = torch.einsum("bhqd,bhkd->bhqk", q, k_cache) * (Dh ** -0.5)
        p = _softmax(scores, axis=-1)
        o = torch.einsum("bhqk,bhkd->bhqd", p, v_cache)
        return (lambda x, *d: x.permute(*d))(o, 0, 2, 1, 3).reshape(B, Sq, H * Dh) @ wo

    def _B_ref(x, k_cache, v_cache, wq, wo):
        B, Sq, D = x.shape
        Hq, Dh = 32, 128
        Hkv = k_cache.shape[1]
        rep = Hq // Hkv
        q = (lambda x, *d: x.permute(*d))((x @ wq).reshape(B, Sq, Hq, Dh), 0, 2, 1, 3)
        k = (lambda x, n, axis: torch.repeat_interleave(x, n, dim=axis))(k_cache, rep, axis=1)
        v = (lambda x, n, axis: torch.repeat_interleave(x, n, dim=axis))(v_cache, rep, axis=1)
        scores = torch.einsum("bhqd,bhkd->bhqk", q, k) * (Dh ** -0.5)
        p = _softmax(scores, axis=-1)
        o = torch.einsum("bhqk,bhkd->bhqd", p, v)
        return (lambda x, *d: x.permute(*d))(o, 0, 2, 1, 3).reshape(B, Sq, Hq * Dh) @ wo

    a = _A_ref(A_x, A_k_cache, A_v_cache, A_wq, A_wo)
    b = _B_ref(B_x, B_k_cache, B_v_cache, B_wq, B_wo)
    return torch.concatenate([a, b], axis=-1)
```

```asm
; @launch grid=(256,1,1) block=(512,1,1) lds=163840
.amdgcn_target "amdgcn-amd-amdhsa--gfx950"
.text
.globl concat_heads__mha_block_cached__gqa_block_cached__near_ridge_kernel
.p2align 8
.type concat_heads__mha_block_cached__gqa_block_cached__near_ridge_kernel,@function
concat_heads__mha_block_cached__gqa_block_cached__near_ridge_kernel:
    s_cmp_ge_u32 s2, 256
    s_cbranch_scc1 concat_heads__mha_block_cached__gqa_block_cached__near_ridge_kernel_end
    s_load_dwordx16 s[4:19], s[0:1], 0
    s_load_dwordx4 s[20:23], s[0:1], 64
    s_load_dwordx2 s[24:25], s[0:1], 96
    s_load_dwordx4 s[92:95], s[0:1], 80
    v_lshrrev_b32 v1, 6, v0
    v_and_b32 v0, 63, v0
    v_readfirstlane_b32 s52, v1
    s_and_b32 s26, s2, 7
    s_lshr_b32 s27, s2, 3
    s_and_b32 s30, s26, 3
    s_lshl_b32 s28, s30, 2
    s_and_b32 s29, s27, 3
    s_add_u32 s28, s28, s29
    s_lshr_b32 s71, s52, 2
    s_and_b32 s76, s52, 3
    s_lshl1_add_u32 s28, s28, s71
    s_lshr_b32 s27, s27, 2
    s_lshr_b32 s26, s26, 2
    s_lshl_b32 s64, s52, 12
    v_lshrrev_b32 v32, 4, v0
    v_and_b32 v33, 15, v0
    v_lshrrev_b32 v34, 2, v0
    v_and_b32 v35, 3, v0
    v_xor_b32 v36, v35, v32
    v_lshlrev_b32 v36, 4, v36
    v_lshl_add_u32 v36, v34, 10, v36
    s_lshl_b32 s57, s52, 14
    v_add_u32 v1, s57, v36
    v_lshlrev_b32 v36, 2, v32
    v_xor_b32 v36, v36, v33
    v_lshlrev_b32 v36, 4, v36
    s_lshl_b32 s57, s76, 16
    v_lshl_add_u32 v37, v32, 13, v36
    v_add_u32 v5, s57, v37
    s_lshl_b32 s58, s76, 12
    v_lshl_add_u32 v37, v32, 8, v36
    v_add_u32 v10, s58, v37
    s_lshl1_add_u32 s57, s30, 0
    s_lshl_b32 s57, s57, 1
    s_and_b32 s57, s57, 15
    s_lshl_b32 s61, s57, 6
    s_lshl_b32 s57, s57, 18
    s_lshl_b32 s62, s28, 8
    s_add_u32 s62, s62, s57
    s_lshl_b32 s65, s52, 10
    s_lshl_b32 s67, s52, 11
    s_waitcnt lgkmcnt(0)
    s_cmp_eq_u32 s26, 0
    s_cselect_b64 s[4:5], s[4:5], s[14:15]
    s_cselect_b64 s[6:7], s[6:7], s[16:17]
    s_cselect_b64 s[8:9], s[8:9], s[18:19]
    s_cselect_b64 s[10:11], s[10:11], s[20:21]
    s_cselect_b64 s[12:13], s[12:13], s[22:23]
    s_lshl_b32 s57, s27, 17
    s_add_u32 s32, s4, s57
    s_addc_u32 s33, s5, 0
    s_mov_b32 s34, 131072
    s_mov_b32 s35, 0x00020000
    s_mov_b32 s36, s10
    s_mov_b32 s37, s11
    s_mov_b32 s38, 4194304
    s_mov_b32 s39, 0x00020000
    s_lshl3_add_u32 s31, s26, s27
    s_lshl_b32 s57, s31, 12
    s_add_u32 s57, s57, 0x2200000
    s_add_u32 s80, s24, s57
    s_addc_u32 s81, s25, 0
    s_mov_b32 s82, 4096
    s_mov_b32 s83, 0x00020000
    s_lshl2_add_u32 s78, s30, s29
    s_lshl_b32 s78, s78, 8
    s_mov_b32 s22, 0
    v_lshlrev_b32 v38, 4, v0
    v_mov_b32 v40, 0
    v_mov_b32 v41, s22
    s_cmp_lg_u32 s52, 0
    s_cbranch_scc1 concat_heads__mha_block_cached__gqa_block_cached__near_ridge_kernel_c0
    s_mov_b64 exec, 0xffff
    buffer_store_dwordx2 v[40:41], v38, s[80:83], s78 offen sc1
    s_mov_b64 exec, -1
concat_heads__mha_block_cached__gqa_block_cached__near_ridge_kernel_c0:
    s_add_u32 m0, s65, 65536
    s_add_u32 s66, s62, 31744
    buffer_load_dwordx4 v1, s[32:35], s61 offen lds
    s_add_u32 m0, s67, 73728
    s_add_u32 s61, s61, 64
    s_and_b32 s61, s61, 1023
    buffer_load_dwordx4 v5, s[36:39], s62 offen nt lds
    s_add_u32 s62, s62, 262144
    s_and_b32 s62, s62, 0x3fffff
    buffer_load_dwordx4 v5, s[36:39], s66 offen offset:1024 nt lds
    s_add_u32 m0, s65, 90112
    s_add_u32 s66, s62, 31744
    buffer_load_dwordx4 v1, s[32:35], s61 offen lds
    s_add_u32 m0, s67, 98304
    s_add_u32 s61, s61, 64
    s_and_b32 s61, s61, 1023
    buffer_load_dwordx4 v5, s[36:39], s62 offen nt lds
    s_add_u32 s62, s62, 262144
    s_and_b32 s62, s62, 0x3fffff
    buffer_load_dwordx4 v5, s[36:39], s66 offen offset:1024 nt lds
    s_add_u32 m0, s65, 114688
    s_add_u32 s66, s62, 31744
    buffer_load_dwordx4 v1, s[32:35], s61 offen lds
    s_add_u32 m0, s67, 122880
    s_add_u32 s61, s61, 64
    s_and_b32 s61, s61, 1023
    buffer_load_dwordx4 v5, s[36:39], s62 offen nt lds
    s_add_u32 s62, s62, 262144
    s_and_b32 s62, s62, 0x3fffff
    buffer_load_dwordx4 v5, s[36:39], s66 offen offset:1024 nt lds
    s_add_u32 m0, s65, 139264
    s_add_u32 s66, s62, 31744
    buffer_load_dwordx4 v1, s[32:35], s61 offen lds
    s_add_u32 m0, s67, 147456
    s_add_u32 s61, s61, 64
    s_and_b32 s61, s61, 1023
    buffer_load_dwordx4 v5, s[36:39], s62 offen nt lds
    s_add_u32 s62, s62, 262144
    s_and_b32 s62, s62, 0x3fffff
    buffer_load_dwordx4 v5, s[36:39], s66 offen offset:1024 nt lds
    v_add_u32 v36, 0, v32
    v_xor_b32 v36, v36, v33
    v_lshlrev_b32 v36, 4, v36
    v_lshl_add_u32 v36, v32, 8, v36
    v_add_u32 v6, s58, v36
    v_add_u32 v220, s58, v36
    v_add_u32 v36, 4, v32
    v_xor_b32 v36, v36, v33
    v_lshlrev_b32 v36, 4, v36
    v_lshl_add_u32 v36, v32, 8, v36
    v_add_u32 v7, s58, v36
    v_add_u32 v221, s58, v36
    v_add_u32 v36, 8, v32
    v_xor_b32 v36, v36, v33
    v_lshlrev_b32 v36, 4, v36
    v_lshl_add_u32 v36, v32, 8, v36
    v_add_u32 v8, s58, v36
    v_add_u32 v222, s58, v36
    v_add_u32 v36, 12, v32
    v_xor_b32 v36, v36, v33
    v_lshlrev_b32 v36, 4, v36
    v_lshl_add_u32 v36, v32, 8, v36
    v_add_u32 v9, s58, v36
    v_add_u32 v223, s58, v36
    s_lshl_b32 s57, s27, 5
    s_add_u32 s57, s57, s28
    s_lshl_b32 s57, s57, 17
    s_add_u32 s40, s6, s57
    s_addc_u32 s41, s7, 0
    s_mov_b32 s42, 131072
    s_mov_b32 s43, 0x00020000
    s_add_u32 s44, s8, s57
    s_addc_u32 s45, s9, 0
    s_mov_b32 s46, 131072
    s_mov_b32 s47, 0x00020000
    s_lshl_b32 s57, s28, 3
    s_add_u32 s57, s57, s27
    s_lshl_b32 s57, s57, 14
    s_add_u32 s72, s12, s57
    s_addc_u32 s73, s13, 0
    s_mov_b32 s74, 16384
    s_mov_b32 s75, 0x00020000
    s_lshl_b32 s57, s26, 3
    s_add_u32 s57, s57, s27
    s_lshl_b32 s57, s57, 2
    s_add_u32 s57, s57, s76
    s_lshl_b32 s57, s57, 5
    s_lshl3_add_u32 s57, s30, s57
    s_lshl_b32 s57, s57, 13
    s_add_u32 s48, s24, s57
    s_addc_u32 s49, s25, 0
    s_mov_b32 s50, 65536
    s_mov_b32 s51, 0x00020000
    s_lshl_b32 s57, s31, 4
    s_add_u32 s16, s94, s57
    s_addc_u32 s17, s95, 0
    s_mov_b32 s18, 16
    s_mov_b32 s19, 0x00020000
    s_mov_b64 s[14:15], s[92:93]
    v_and_b32 v36, 31, v0
    v_lshrrev_b32 v37, 5, v0
    v_and_b32 v42, 3, v34
    v_xor_b32 v42, v42, v37
    v_lshlrev_b32 v42, 4, v42
    v_lshl_add_u32 v42, v36, 6, v42
    s_lshl_b32 s57, s76, 11
    s_add_u32 s57, s57, 65536
    v_add_u32 v208, s57, v42
    v_xor_b32 v209, 32, v208
    v_add_u32 v210, 49152, v208
    v_add_u32 v211, 49152, v209
    s_lshl_b32 s58, s71, 14
    v_xor_b32 v42, v33, v37
    v_lshlrev_b32 v42, 4, v42
    v_lshl_add_u32 v42, v36, 8, v42
    v_add_u32 v13, s58, v42
    v_lshrrev_b32 v42, 2, v33
    v_and_b32 v43, 3, v0
    v_and_b32 v44, 1, v32
    v_lshlrev_b32 v44, 5, v44
    v_lshl_add_u32 v44, v42, 6, v44
    v_lshl_add_u32 v44, v42, 8, v44
    v_lshl_add_u32 v45, v43, 3, v44
    v_lshl_add_u32 v45, v37, 10, v45
    v_add_u32 v14, s58, v45
    v_lshrrev_b32 v45, 1, v43
    v_and_b32 v43, 1, v43
    v_lshl_add_u32 v45, v43, 1, v45
    v_lshl_add_u32 v45, v45, 3, v44
    v_lshl_add_u32 v45, v37, 11, v45
    s_lshl_b32 s57, s71, 13
    s_add_u32 s57, s57, 73728
    v_add_u32 v212, s57, v45
    v_lshlrev_b32 v31, 4, v0
    s_mov_b32 s59, 0x3e0293ee
    s_mov_b32 s60, 0x427af233
    s_mov_b32 s55, 0
    s_add_u32 s70, s64, 32768
    s_mov_b32 s3, 0
    s_add_u32 s56, s28, s27
    s_and_b32 s56, s56, 0
    s_lshl_b32 s56, s56, 14
    s_add_u32 s63, s56, 16384
    s_and_b32 s63, s63, 0x1ffff
    s_mov_b64 s[20:21], s[72:73]
    s_mov_b64 s[72:73], s[40:41]
    s_mov_b32 s74, 131072
    s_mov_b32 s3, s56
    s_mov_b32 s70, s64
    v_xor_b32 v213, 64, v212
    v_xor_b32 v214, 128, v212
    v_xor_b32 v215, 192, v212
    v_add_u32 v216, 49152, v212
    v_add_u32 v217, 49152, v213
    v_add_u32 v218, 49152, v214
    v_add_u32 v219, 49152, v215
    v_mov_b32 v64, 0
    v_mov_b32 v65, 0
    v_mov_b32 v66, 0
    v_mov_b32 v67, 0
    v_mov_b32 v68, 0
    v_mov_b32 v69, 0
    v_mov_b32 v70, 0
    v_mov_b32 v71, 0
    v_mov_b32 v72, 0
    v_mov_b32 v73, 0
    v_mov_b32 v74, 0
    v_mov_b32 v75, 0
    v_mov_b32 v76, 0
    v_mov_b32 v77, 0
    v_mov_b32 v78, 0
    v_mov_b32 v79, 0
    v_mov_b32 v80, 0
    v_mov_b32 v81, 0
    v_mov_b32 v82, 0
    v_mov_b32 v83, 0
    v_mov_b32 v84, 0
    v_mov_b32 v85, 0
    v_mov_b32 v86, 0
    v_mov_b32 v87, 0
    v_mov_b32 v88, 0
    v_mov_b32 v89, 0
    v_mov_b32 v90, 0
    v_mov_b32 v91, 0
    v_mov_b32 v92, 0
    v_mov_b32 v93, 0
    v_mov_b32 v94, 0
    v_mov_b32 v95, 0
    v_mov_b32 v96, 0
    v_mov_b32 v97, 0
    v_mov_b32 v98, 0
    v_mov_b32 v99, 0
    v_mov_b32 v100, 0
    v_mov_b32 v101, 0
    v_mov_b32 v102, 0
    v_mov_b32 v103, 0
    v_mov_b32 v104, 0
    v_mov_b32 v105, 0
    v_mov_b32 v106, 0
    v_mov_b32 v107, 0
    v_mov_b32 v108, 0
    v_mov_b32 v109, 0
    v_mov_b32 v110, 0
    v_mov_b32 v111, 0
    v_mov_b32 v112, 0
    v_mov_b32 v113, 0
    v_mov_b32 v114, 0
    v_mov_b32 v115, 0
    v_mov_b32 v116, 0
    v_mov_b32 v117, 0
    v_mov_b32 v118, 0
    v_mov_b32 v119, 0
    v_mov_b32 v120, 0
    v_mov_b32 v121, 0
    v_mov_b32 v122, 0
    v_mov_b32 v123, 0
    v_mov_b32 v124, 0
    v_mov_b32 v125, 0
    v_mov_b32 v126, 0
    v_mov_b32 v127, 0
    s_waitcnt vmcnt(9)
    s_barrier
    ds_read_b128 v[192:195], v208 offset:0
    ds_read_b128 v[196:199], v209 offset:0
    ds_read_b64_tr_b16 v[128:129], v212 offset:0
    ds_read_b64_tr_b16 v[130:131], v212 offset:1024
    ds_read_b64_tr_b16 v[132:133], v213 offset:0
    ds_read_b64_tr_b16 v[134:135], v213 offset:1024
    ds_read_b64_tr_b16 v[136:137], v214 offset:0
    ds_read_b64_tr_b16 v[138:139], v214 offset:1024
    ds_read_b64_tr_b16 v[140:141], v215 offset:0
    ds_read_b64_tr_b16 v[142:143], v215 offset:1024
    ds_read_b64_tr_b16 v[144:145], v212 offset:4096
    ds_read_b64_tr_b16 v[146:147], v212 offset:5120
    ds_read_b64_tr_b16 v[148:149], v213 offset:4096
    ds_read_b64_tr_b16 v[150:151], v213 offset:5120
    ds_read_b64_tr_b16 v[152:153], v214 offset:4096
    ds_read_b64_tr_b16 v[154:155], v214 offset:5120
    ds_read_b64_tr_b16 v[156:157], v215 offset:4096
    ds_read_b64_tr_b16 v[158:159], v215 offset:5120
concat_heads__mha_block_cached__gqa_block_cached__near_ridge_kernel_q:
    s_waitcnt vmcnt(9) lgkmcnt(0)
    s_cmp_lg_u32 s55, 0
    s_cbranch_scc1 concat_heads__mha_block_cached__gqa_block_cached__near_ridge_kernel_w0
    s_waitcnt vmcnt(6)
concat_heads__mha_block_cached__gqa_block_cached__near_ridge_kernel_w0:
    s_barrier
    v_mfma_f32_32x32x16_bf16 v[64:79], v[128:131], v[192:195], v[64:79]
    ds_read_b128 v[200:203], v208 offset:24576
    ds_read_b128 v[204:207], v209 offset:24576
    ds_read_b64_tr_b16 v[160:161], v212 offset:24576
    s_add_u32 m0, s65, 65536
    s_add_u32 s66, s62, 31744
    buffer_load_dwordx4 v1, s[32:35], s61 offen lds
    s_add_u32 m0, s67, 73728
    s_add_u32 s61, s61, 64
    s_and_b32 s61, s61, 1023
    v_mfma_f32_32x32x16_bf16 v[80:95], v[132:135], v[192:195], v[80:95]
    ds_read_b64_tr_b16 v[162:163], v212 offset:25600
    ds_read_b64_tr_b16 v[164:165], v213 offset:24576
    ds_read_b64_tr_b16 v[166:167], v213 offset:25600
    buffer_load_dwordx4 v5, s[36:39], s62 offen nt lds
    s_add_u32 s62, s62, 262144
    s_and_b32 s62, s62, 0x3fffff
    v_mfma_f32_32x32x16_bf16 v[96:111], v[136:139], v[192:195], v[96:111]
    ds_read_b64_tr_b16 v[168:169], v214 offset:24576
    ds_read_b64_tr_b16 v[170:171], v214 offset:25600
    ds_read_b64_tr_b16 v[172:173], v215 offset:24576
    buffer_load_dwordx4 v5, s[36:39], s66 offen offset:1024 nt lds
    v_mfma_f32_32x32x16_bf16 v[112:127], v[140:143], v[192:195], v[112:127]
    ds_read_b64_tr_b16 v[174:175], v215 offset:25600
    ds_read_b64_tr_b16 v[176:177], v212 offset:28672
    ds_read_b64_tr_b16 v[178:179], v212 offset:29696
    s_mov_b32 m0, s70
    s_cmp_eq_u32 s55, 2
    s_cbranch_scc1 concat_heads__mha_block_cached__gqa_block_cached__near_ridge_kernel_e0
    buffer_load_dwordx4 v220, s[72:75], s3 offen offset:0 nt lds
    s_branch concat_heads__mha_block_cached__gqa_block_cached__near_ridge_kernel_f0
concat_heads__mha_block_cached__gqa_block_cached__near_ridge_kernel_e0:
    buffer_load_dwordx4 v[52:55], v220, s[72:75], s3 offen offset:0
concat_heads__mha_block_cached__gqa_block_cached__near_ridge_kernel_f0:
    v_mfma_f32_32x32x16_bf16 v[64:79], v[144:147], v[196:199], v[64:79]
    ds_read_b64_tr_b16 v[180:181], v213 offset:28672
    ds_read_b64_tr_b16 v[182:183], v213 offset:29696
    ds_read_b64_tr_b16 v[184:185], v214 offset:28672
    v_mfma_f32_32x32x16_bf16 v[80:95], v[148:151], v[196:199], v[80:95]
    ds_read_b64_tr_b16 v[186:187], v214 offset:29696
    ds_read_b64_tr_b16 v[188:189], v215 offset:28672
    ds_read_b64_tr_b16 v[190:191], v215 offset:29696
    v_mfma_f32_32x32x16_bf16 v[96:111], v[152:155], v[196:199], v[96:111]
    v_mfma_f32_32x32x16_bf16 v[112:127], v[156:159], v[196:199], v[112:127]
    s_waitcnt vmcnt(9) lgkmcnt(0)
    s_cmp_lg_u32 s55, 0
    s_cbranch_scc1 concat_heads__mha_block_cached__gqa_block_cached__near_ridge_kernel_w1
    s_waitcnt vmcnt(7)
concat_heads__mha_block_cached__gqa_block_cached__near_ridge_kernel_w1:
    s_barrier
    v_mfma_f32_32x32x16_bf16 v[64:79], v[160:163], v[200:203], v[64:79]
    ds_read_b128 v[192:195], v210 offset:0
    ds_read_b128 v[196:199], v211 offset:0
    ds_read_b64_tr_b16 v[128:129], v216 offset:0
    s_add_u32 m0, s65, 90112
    s_add_u32 s66, s62, 31744
    buffer_load_dwordx4 v1, s[32:35], s61 offen lds
    s_add_u32 m0, s67, 98304
    s_add_u32 s61, s61, 64
    s_and_b32 s61, s61, 1023
    v_mfma_f32_32x32x16_bf16 v[80:95], v[164:167], v[200:203], v[80:95]
    ds_read_b64_tr_b16 v[130:131], v216 offset:1024
    ds_read_b64_tr_b16 v[132:133], v217 offset:0
    ds_read_b64_tr_b16 v[134:135], v217 offset:1024
    buffer_load_dwordx4 v5, s[36:39], s62 offen nt lds
    s_add_u32 s62, s62, 262144
    s_and_b32 s62, s62, 0x3fffff
    v_mfma_f32_32x32x16_bf16 v[96:111], v[168:171], v[200:203], v[96:111]
    ds_read_b64_tr_b16 v[136:137], v218 offset:0
    ds_read_b64_tr_b16 v[138:139], v218 offset:1024
    ds_read_b64_tr_b16 v[140:141], v219 offset:0
    buffer_load_dwordx4 v5, s[36:39], s66 offen offset:1024 nt lds
    v_mfma_f32_32x32x16_bf16 v[112:127], v[172:175], v[200:203], v[112:127]
    ds_read_b64_tr_b16 v[142:143], v219 offset:1024
    ds_read_b64_tr_b16 v[144:145], v216 offset:4096
    ds_read_b64_tr_b16 v[146:147], v216 offset:5120
    s_mov_b32 m0, s70
    s_cmp_eq_u32 s55, 2
    s_cbranch_scc1 concat_heads__mha_block_cached__gqa_block_cached__near_ridge_kernel_e1
    buffer_load_dwordx4 v221, s[72:75], s3 offen offset:1024 nt lds
    s_branch concat_heads__mha_block_cached__gqa_block_cached__near_ridge_kernel_f1
concat_heads__mha_block_cached__gqa_block_cached__near_ridge_kernel_e1:
    buffer_load_dwordx4 v[52:55], v221, s[72:75], s3 offen offset:1024
concat_heads__mha_block_cached__gqa_block_cached__near_ridge_kernel_f1:
    v_mfma_f32_32x32x16_bf16 v[64:79], v[176:179], v[204:207], v[64:79]
    ds_read_b64_tr_b16 v[148:149], v217 offset:4096
    ds_read_b64_tr_b16 v[150:151], v217 offset:5120
    ds_read_b64_tr_b16 v[152:153], v218 offset:4096
    v_mfma_f32_32x32x16_bf16 v[80:95], v[180:183], v[204:207], v[80:95]
    ds_read_b64_tr_b16 v[154:155], v218 offset:5120
    ds_read_b64_tr_b16 v[156:157], v219 offset:4096
    ds_read_b64_tr_b16 v[158:159], v219 offset:5120
    v_mfma_f32_32x32x16_bf16 v[96:111], v[184:187], v[204:207], v[96:111]
    v_mfma_f32_32x32x16_bf16 v[112:127], v[188:191], v[204:207], v[112:127]
    s_waitcnt vmcnt(9) lgkmcnt(0)
    s_cmp_lg_u32 s55, 0
    s_cbranch_scc1 concat_heads__mha_block_cached__gqa_block_cached__near_ridge_kernel_w2
    s_waitcnt vmcnt(8)
concat_heads__mha_block_cached__gqa_block_cached__near_ridge_kernel_w2:
    s_barrier
    v_mfma_f32_32x32x16_bf16 v[64:79], v[128:131], v[192:195], v[64:79]
    ds_read_b128 v[200:203], v210 offset:24576
    ds_read_b128 v[204:207], v211 offset:24576
    ds_read_b64_tr_b16 v[160:161], v216 offset:24576
    s_add_u32 m0, s65, 114688
    s_add_u32 s66, s62, 31744
    buffer_load_dwordx4 v1, s[32:35], s61 offen lds
    s_add_u32 m0, s67, 122880
    s_add_u32 s61, s61, 64
    s_and_b32 s61, s61, 1023
    v_mfma_f32_32x32x16_bf16 v[80:95], v[132:135], v[192:195], v[80:95]
    ds_read_b64_tr_b16 v[162:163], v216 offset:25600
    ds_read_b64_tr_b16 v[164:165], v217 offset:24576
    ds_read_b64_tr_b16 v[166:167], v217 offset:25600
    buffer_load_dwordx4 v5, s[36:39], s62 offen nt lds
    s_add_u32 s62, s62, 262144
    s_and_b32 s62, s62, 0x3fffff
    v_mfma_f32_32x32x16_bf16 v[96:111], v[136:139], v[192:195], v[96:111]
    ds_read_b64_tr_b16 v[168:169], v218 offset:24576
    ds_read_b64_tr_b16 v[170:171], v218 offset:25600
    ds_read_b64_tr_b16 v[172:173], v219 offset:24576
    buffer_load_dwordx4 v5, s[36:39], s66 offen offset:1024 nt lds
    v_mfma_f32_32x32x16_bf16 v[112:127], v[140:143], v[192:195], v[112:127]
    ds_read_b64_tr_b16 v[174:175], v219 offset:25600
    ds_read_b64_tr_b16 v[176:177], v216 offset:28672
    ds_read_b64_tr_b16 v[178:179], v216 offset:29696
    s_mov_b32 m0, s70
    s_cmp_eq_u32 s55, 2
    s_cbranch_scc1 concat_heads__mha_block_cached__gqa_block_cached__near_ridge_kernel_e2
    buffer_load_dwordx4 v222, s[72:75], s3 offen offset:2048 nt lds
    s_branch concat_heads__mha_block_cached__gqa_block_cached__near_ridge_kernel_f2
concat_heads__mha_block_cached__gqa_block_cached__near_ridge_kernel_e2:
    buffer_load_dwordx4 v[52:55], v222, s[72:75], s3 offen offset:2048
concat_heads__mha_block_cached__gqa_block_cached__near_ridge_kernel_f2:
    v_mfma_f32_32x32x16_bf16 v[64:79], v[144:147], v[196:199], v[64:79]
    ds_read_b64_tr_b16 v[180:181], v217 offset:28672
    ds_read_b64_tr_b16 v[182:183], v217 offset:29696
    ds_read_b64_tr_b16 v[184:185], v218 offset:28672
    v_mfma_f32_32x32x16_bf16 v[80:95], v[148:151], v[196:199], v[80:95]
    ds_read_b64_tr_b16 v[186:187], v218 offset:29696
    ds_read_b64_tr_b16 v[188:189], v219 offset:28672
    ds_read_b64_tr_b16 v[190:191], v219 offset:29696
    v_mfma_f32_32x32x16_bf16 v[96:111], v[152:155], v[196:199], v[96:111]
    v_mfma_f32_32x32x16_bf16 v[112:127], v[156:159], v[196:199], v[112:127]
    s_waitcnt vmcnt(9) lgkmcnt(0)
    s_barrier
    v_mfma_f32_32x32x16_bf16 v[64:79], v[160:163], v[200:203], v[64:79]
    ds_read_b128 v[192:195], v208 offset:0
    ds_read_b128 v[196:199], v209 offset:0
    ds_read_b64_tr_b16 v[128:129], v212 offset:0
    s_add_u32 m0, s65, 139264
    s_add_u32 s66, s62, 31744
    buffer_load_dwordx4 v1, s[32:35], s61 offen lds
    s_add_u32 m0, s67, 147456
    s_add_u32 s61, s61, 64
    s_and_b32 s61, s61, 1023
    v_mfma_f32_32x32x16_bf16 v[80:95], v[164:167], v[200:203], v[80:95]
    ds_read_b64_tr_b16 v[130:131], v212 offset:1024
    ds_read_b64_tr_b16 v[132:133], v213 offset:0
    ds_read_b64_tr_b16 v[134:135], v213 offset:1024
    buffer_load_dwordx4 v5, s[36:39], s62 offen nt lds
    s_add_u32 s62, s62, 262144
    s_and_b32 s62, s62, 0x3fffff
    v_mfma_f32_32x32x16_bf16 v[96:111], v[168:171], v[200:203], v[96:111]
    ds_read_b64_tr_b16 v[136:137], v214 offset:0
    ds_read_b64_tr_b16 v[138:139], v214 offset:1024
    ds_read_b64_tr_b16 v[140:141], v215 offset:0
    buffer_load_dwordx4 v5, s[36:39], s66 offen offset:1024 nt lds
    v_mfma_f32_32x32x16_bf16 v[112:127], v[172:175], v[200:203], v[112:127]
    ds_read_b64_tr_b16 v[142:143], v215 offset:1024
    ds_read_b64_tr_b16 v[144:145], v212 offset:4096
    ds_read_b64_tr_b16 v[146:147], v212 offset:5120
    s_mov_b32 m0, s70
    s_cmp_eq_u32 s55, 2
    s_cbranch_scc1 concat_heads__mha_block_cached__gqa_block_cached__near_ridge_kernel_e3
    buffer_load_dwordx4 v223, s[72:75], s3 offen offset:3072 nt lds
    s_branch concat_heads__mha_block_cached__gqa_block_cached__near_ridge_kernel_f3
concat_heads__mha_block_cached__gqa_block_cached__near_ridge_kernel_e3:
    buffer_load_dwordx4 v[52:55], v223, s[72:75], s3 offen offset:3072
concat_heads__mha_block_cached__gqa_block_cached__near_ridge_kernel_f3:
    v_mfma_f32_32x32x16_bf16 v[64:79], v[176:179], v[204:207], v[64:79]
    ds_read_b64_tr_b16 v[148:149], v213 offset:4096
    ds_read_b64_tr_b16 v[150:151], v213 offset:5120
    ds_read_b64_tr_b16 v[152:153], v214 offset:4096
    v_mfma_f32_32x32x16_bf16 v[80:95], v[180:183], v[204:207], v[80:95]
    ds_read_b64_tr_b16 v[154:155], v214 offset:5120
    ds_read_b64_tr_b16 v[156:157], v215 offset:4096
    ds_read_b64_tr_b16 v[158:159], v215 offset:5120
    v_mfma_f32_32x32x16_bf16 v[96:111], v[184:187], v[204:207], v[96:111]
    v_mfma_f32_32x32x16_bf16 v[112:127], v[188:191], v[204:207], v[112:127]
    s_xor_b32 s70, s70, 32768
    s_mov_b32 s74, 16384
    s_cmp_eq_u32 s55, 0
    s_cselect_b64 s[72:73], s[44:45], s[20:21]
    s_cselect_b32 s74, s46, s74
    s_cselect_b32 s3, s56, 0
    v_mov_b32 v220, v10
    v_mov_b32 v221, v10
    v_mov_b32 v222, v10
    v_mov_b32 v223, v10
concat_heads__mha_block_cached__gqa_block_cached__near_ridge_kernel_q1:
    s_add_u32 s55, s55, 1
    s_cmp_lt_u32 s55, 3
    s_cbranch_scc1 concat_heads__mha_block_cached__gqa_block_cached__near_ridge_kernel_q
    s_mov_b32 s54, 65536
    s_mov_b32 s53, 98304
    s_waitcnt vmcnt(9) lgkmcnt(0)
    s_barrier
    v_mfma_f32_32x32x16_bf16 v[64:79], v[128:131], v[192:195], v[64:79]
    ds_read_b128 v[200:203], v208 offset:24576
    ds_read_b128 v[204:207], v209 offset:24576
    ds_read_b64_tr_b16 v[160:161], v212 offset:24576
    v_mfma_f32_32x32x16_bf16 v[80:95], v[132:135], v[192:195], v[80:95]
    ds_read_b64_tr_b16 v[162:163], v212 offset:25600
    ds_read_b64_tr_b16 v[164:165], v213 offset:24576
    ds_read_b64_tr_b16 v[166:167], v213 offset:25600
    v_mfma_f32_32x32x16_bf16 v[96:111], v[136:139], v[192:195], v[96:111]
    ds_read_b64_tr_b16 v[168:169], v214 offset:24576
    ds_read_b64_tr_b16 v[170:171], v214 offset:25600
    ds_read_b64_tr_b16 v[172:173], v215 offset:24576
    v_mfma_f32_32x32x16_bf16 v[112:127], v[140:143], v[192:195], v[112:127]
    ds_read_b64_tr_b16 v[174:175], v215 offset:25600
    ds_read_b64_tr_b16 v[176:177], v212 offset:28672
    ds_read_b64_tr_b16 v[178:179], v212 offset:29696
    v_mfma_f32_32x32x16_bf16 v[64:79], v[144:147], v[196:199], v[64:79]
    ds_read_b64_tr_b16 v[180:181], v213 offset:28672
    ds_read_b64_tr_b16 v[182:183], v213 offset:29696
    ds_read_b64_tr_b16 v[184:185], v214 offset:28672
    v_mfma_f32_32x32x16_bf16 v[80:95], v[148:151], v[196:199], v[80:95]
    ds_read_b64_tr_b16 v[186:187], v214 offset:29696
    ds_read_b64_tr_b16 v[188:189], v215 offset:28672
    ds_read_b64_tr_b16 v[190:191], v215 offset:29696
    v_mfma_f32_32x32x16_bf16 v[96:111], v[152:155], v[196:199], v[96:111]
    v_mfma_f32_32x32x16_bf16 v[112:127], v[156:159], v[196:199], v[112:127]
    s_waitcnt vmcnt(5) lgkmcnt(0)
    s_barrier
    v_mfma_f32_32x32x16_bf16 v[64:79], v[160:163], v[200:203], v[64:79]
    ds_read_b128 v[192:195], v210 offset:0
    ds_read_b128 v[196:199], v211 offset:0
    ds_read_b64_tr_b16 v[128:129], v216 offset:0
    s_add_u32 m0, s54, s64
    s_nop 0
    buffer_load_dwordx4 v6, s[40:43], s63 offen offset:0 nt lds
    buffer_load_dwordx4 v7, s[40:43], s63 offen offset:1024 nt lds
    buffer_load_dwordx4 v8, s[40:43], s63 offen offset:2048 nt lds
    buffer_load_dwordx4 v9, s[40:43], s63 offen offset:3072 nt lds
    v_mfma_f32_32x32x16_bf16 v[80:95], v[164:167], v[200:203], v[80:95]
    ds_read_b64_tr_b16 v[130:131], v216 offset:1024
    ds_read_b64_tr_b16 v[132:133], v217 offset:0
    ds_read_b64_tr_b16 v[134:135], v217 offset:1024
    v_mfma_f32_32x32x16_bf16 v[96:111], v[168:171], v[200:203], v[96:111]
    ds_read_b64_tr_b16 v[136:137], v218 offset:0
    ds_read_b64_tr_b16 v[138:139], v218 offset:1024
    ds_read_b64_tr_b16 v[140:141], v219 offset:0
    v_mfma_f32_32x32x16_bf16 v[112:127], v[172:175], v[200:203], v[112:127]
    ds_read_b64_tr_b16 v[142:143], v219 offset:1024
    ds_read_b64_tr_b16 v[144:145], v216 offset:4096
    ds_read_b64_tr_b16 v[146:147], v216 offset:5120
    v_mfma_f32_32x32x16_bf16 v[64:79], v[176:179], v[204:207], v[64:79]
    ds_read_b64_tr_b16 v[148:149], v217 offset:4096
    ds_read_b64_tr_b16 v[150:151], v217 offset:5120
    ds_read_b64_tr_b16 v[152:153], v218 offset:4096
    v_mfma_f32_32x32x16_bf16 v[80:95], v[180:183], v[204:207], v[80:95]
    ds_read_b64_tr_b16 v[154:155], v218 offset:5120
    ds_read_b64_tr_b16 v[156:157], v219 offset:4096
    ds_read_b64_tr_b16 v[158:159], v219 offset:5120
    v_mfma_f32_32x32x16_bf16 v[96:111], v[184:187], v[204:207], v[96:111]
    v_mfma_f32_32x32x16_bf16 v[112:127], v[188:191], v[204:207], v[112:127]
    s_waitcnt vmcnt(5) lgkmcnt(0)
    s_barrier
    v_mfma_f32_32x32x16_bf16 v[64:79], v[128:131], v[192:195], v[64:79]
    ds_read_b128 v[200:203], v210 offset:24576
    ds_read_b128 v[204:207], v211 offset:24576
    ds_read_b64_tr_b16 v[160:161], v216 offset:24576
    s_add_u32 m0, s53, s64
    s_nop 0
    buffer_load_dwordx4 v10, s[44:47], s63 offen offset:0 nt lds
    buffer_load_dwordx4 v10, s[44:47], s63 offen offset:1024 nt lds
    buffer_load_dwordx4 v10, s[44:47], s63 offen offset:2048 nt lds
    buffer_load_dwordx4 v10, s[44:47], s63 offen offset:3072 nt lds
    s_add_u32 s63, s63, 16384
    s_and_b32 s63, s63, 0x1ffff
    v_mfma_f32_32x32x16_bf16 v[80:95], v[132:135], v[192:195], v[80:95]
    ds_read_b64_tr_b16 v[162:163], v216 offset:25600
    ds_read_b64_tr_b16 v[164:165], v217 offset:24576
    ds_read_b64_tr_b16 v[166:167], v217 offset:25600
    v_mfma_f32_32x32x16_bf16 v[96:111], v[136:139], v[192:195], v[96:111]
    ds_read_b64_tr_b16 v[168:169], v218 offset:24576
    ds_read_b64_tr_b16 v[170:171], v218 offset:25600
    ds_read_b64_tr_b16 v[172:173], v219 offset:24576
    v_mfma_f32_32x32x16_bf16 v[112:127], v[140:143], v[192:195], v[112:127]
    ds_read_b64_tr_b16 v[174:175], v219 offset:25600
    ds_read_b64_tr_b16 v[176:177], v216 offset:28672
    ds_read_b64_tr_b16 v[178:179], v216 offset:29696
    v_mfma_f32_32x32x16_bf16 v[64:79], v[144:147], v[196:199], v[64:79]
    ds_read_b64_tr_b16 v[180:181], v217 offset:28672
    ds_read_b64_tr_b16 v[182:183], v217 offset:29696
    ds_read_b64_tr_b16 v[184:185], v218 offset:28672
    v_mfma_f32_32x32x16_bf16 v[80:95], v[148:151], v[196:199], v[80:95]
    ds_read_b64_tr_b16 v[186:187], v218 offset:29696
    ds_read_b64_tr_b16 v[188:189], v219 offset:28672
    ds_read_b64_tr_b16 v[190:191], v219 offset:29696
    v_mfma_f32_32x32x16_bf16 v[96:111], v[152:155], v[196:199], v[96:111]
    v_mfma_f32_32x32x16_bf16 v[112:127], v[156:159], v[196:199], v[112:127]
    s_waitcnt lgkmcnt(0)
    v_mfma_f32_32x32x16_bf16 v[64:79], v[160:163], v[200:203], v[64:79]
    v_mfma_f32_32x32x16_bf16 v[80:95], v[164:167], v[200:203], v[80:95]
    v_mfma_f32_32x32x16_bf16 v[96:111], v[168:171], v[200:203], v[96:111]
    v_mfma_f32_32x32x16_bf16 v[112:127], v[172:175], v[200:203], v[112:127]
    v_mfma_f32_32x32x16_bf16 v[64:79], v[176:179], v[204:207], v[64:79]
    v_mfma_f32_32x32x16_bf16 v[80:95], v[180:183], v[204:207], v[80:95]
    v_mfma_f32_32x32x16_bf16 v[96:111], v[184:187], v[204:207], v[96:111]
    v_mfma_f32_32x32x16_bf16 v[112:127], v[188:191], v[204:207], v[112:127]
    s_mov_b32 s54, 131072
    s_mov_b32 s53, 0
    s_nop 7
    v_cvt_pk_bf16_f32 v128, v64, v65
    v_cvt_pk_bf16_f32 v129, v66, v67
    v_cvt_pk_bf16_f32 v130, v68, v69
    v_cvt_pk_bf16_f32 v131, v70, v71
    v_cvt_pk_bf16_f32 v132, v72, v73
    v_cvt_pk_bf16_f32 v133, v74, v75
    v_cvt_pk_bf16_f32 v134, v76, v77
    v_cvt_pk_bf16_f32 v135, v78, v79
    v_cvt_pk_bf16_f32 v136, v80, v81
    v_cvt_pk_bf16_f32 v137, v82, v83
    v_cvt_pk_bf16_f32 v138, v84, v85
    v_cvt_pk_bf16_f32 v139, v86, v87
    v_cvt_pk_bf16_f32 v140, v88, v89
    v_cvt_pk_bf16_f32 v141, v90, v91
    v_cvt_pk_bf16_f32 v142, v92, v93
    v_cvt_pk_bf16_f32 v143, v94, v95
    v_cvt_pk_bf16_f32 v144, v96, v97
    v_cvt_pk_bf16_f32 v145, v98, v99
    v_cvt_pk_bf16_f32 v146, v100, v101
    v_cvt_pk_bf16_f32 v147, v102, v103
    v_cvt_pk_bf16_f32 v148, v104, v105
    v_cvt_pk_bf16_f32 v149, v106, v107
    v_cvt_pk_bf16_f32 v150, v108, v109
    v_cvt_pk_bf16_f32 v151, v110, v111
    v_cvt_pk_bf16_f32 v152, v112, v113
    v_cvt_pk_bf16_f32 v153, v114, v115
    v_cvt_pk_bf16_f32 v154, v116, v117
    v_cvt_pk_bf16_f32 v155, v118, v119
    v_cvt_pk_bf16_f32 v156, v120, v121
    v_cvt_pk_bf16_f32 v157, v122, v123
    v_cvt_pk_bf16_f32 v158, v124, v125
    v_cvt_pk_bf16_f32 v159, v126, v127
    v_mov_b32 v64, 0
    v_mov_b32 v65, 0
    v_mov_b32 v66, 0
    v_mov_b32 v67, 0
    v_mov_b32 v68, 0
    v_mov_b32 v69, 0
    v_mov_b32 v70, 0
    v_mov_b32 v71, 0
    v_mov_b32 v72, 0
    v_mov_b32 v73, 0
    v_mov_b32 v74, 0
    v_mov_b32 v75, 0
    v_mov_b32 v76, 0
    v_mov_b32 v77, 0
    v_mov_b32 v78, 0
    v_mov_b32 v79, 0
    v_mov_b32 v80, 0
    v_mov_b32 v81, 0
    v_mov_b32 v82, 0
    v_mov_b32 v83, 0
    v_mov_b32 v84, 0
    v_mov_b32 v85, 0
    v_mov_b32 v86, 0
    v_mov_b32 v87, 0
    v_mov_b32 v88, 0
    v_mov_b32 v89, 0
    v_mov_b32 v90, 0
    v_mov_b32 v91, 0
    v_mov_b32 v92, 0
    v_mov_b32 v93, 0
    v_mov_b32 v94, 0
    v_mov_b32 v95, 0
    v_mov_b32 v96, 0
    v_mov_b32 v97, 0
    v_mov_b32 v98, 0
    v_mov_b32 v99, 0
    v_mov_b32 v100, 0
    v_mov_b32 v101, 0
    v_mov_b32 v102, 0
    v_mov_b32 v103, 0
    v_mov_b32 v104, 0
    v_mov_b32 v105, 0
    v_mov_b32 v106, 0
    v_mov_b32 v107, 0
    v_mov_b32 v108, 0
    v_mov_b32 v109, 0
    v_mov_b32 v110, 0
    v_mov_b32 v111, 0
    v_mov_b32 v112, 0
    v_mov_b32 v113, 0
    v_mov_b32 v114, 0
    v_mov_b32 v115, 0
    v_mov_b32 v116, 0
    v_mov_b32 v117, 0
    v_mov_b32 v118, 0
    v_mov_b32 v119, 0
    v_mov_b32 v120, 0
    v_mov_b32 v121, 0
    v_mov_b32 v122, 0
    v_mov_b32 v123, 0
    v_mov_b32 v124, 0
    v_mov_b32 v125, 0
    v_mov_b32 v126, 0
    v_mov_b32 v127, 0
    v_mov_b32 v24, 0xff7fffff
    v_mov_b32 v25, 0
    v_mov_b32 v30, 0
    s_mov_b32 s55, 0
    s_mov_b32 s32, s12
    s_mov_b32 s33, s13
    s_mov_b32 s34, 4194304
    s_mov_b32 s35, 0x00020000
    s_lshl_b32 s57, s31, 20
    s_add_u32 s57, s57, 0x1000000
    s_add_u32 s36, s24, s57
    s_addc_u32 s37, s25, 0
    s_mov_b32 s38, 1048576
    s_mov_b32 s39, 0x00020000
    s_lshl_b32 s57, s27, 18
    s_lshl_b32 s58, s26, 10
    s_add_u32 s57, s57, s58
    s_sub_u32 s58, 0x200000, s57
    s_add_u32 s72, s14, s57
    s_addc_u32 s73, s15, 0
    s_mov_b32 s74, s58
    s_mov_b32 s75, 0x00020000
    v_and_b32 v36, 0xff, v10
    v_lshrrev_b32 v37, 8, v10
    v_lshl_add_u32 v240, v37, 10, v36
    v_add_u32 v241, 3072, v240
    v_add_u32 v242, 6144, v240
    v_add_u32 v243, 9216, v240
    s_lshl_b32 s79, s30, 20
    s_lshl_b32 s57, s71, 17
    s_add_u32 s79, s79, s57
    s_lshl_b32 s57, s29, 8
    s_add_u32 s79, s79, s57
    s_lshl_b32 s68, s29, 1
    v_mov_b32 v15, 1
    s_cmp_lg_u32 s52, 0
    s_cbranch_scc1 concat_heads__mha_block_cached__gqa_block_cached__near_ridge_kernel_c1
    s_mov_b64 exec, 1
    buffer_atomic_add v15, off, s[16:19], 0 sc1
    s_mov_b64 exec, -1
concat_heads__mha_block_cached__gqa_block_cached__near_ridge_kernel_c1:
    v_and_b32 v2, 3, v0
    v_max_u32 v2, 1, v2
    v_xor_b32 v3, s30, v2
    v_xor_b32 v2, s29, v2
    s_lshl_b32 s57, s52, 4
    v_lshlrev_b32 v2, 8, v2
    v_lshlrev_b32 v3, 10, v3
    v_add_u32 v2, s57, v2
    v_add_u32 v3, s57, v3
    s_add_u32 s78, s78, s57
    s_lshl_b32 s67, s30, 10
    v_mov_b32 v4, 1
    v_mov_b32 v50, 0
    v_mov_b32 v48, 0
    v_mov_b32 v49, 0
    v_add_u32 v16, s53, v13
    v_xor_b32 v17, 32, v16
    v_xor_b32 v18, 64, v16
    v_xor_b32 v19, 96, v16
    v_xor_b32 v20, 128, v16
    v_xor_b32 v21, 160, v16
    v_xor_b32 v22, 192, v16
    v_xor_b32 v23, 224, v16
    ds_read_b128 v[208:211], v16 offset:0
    ds_read_b128 v[212:215], v17 offset:0
    ds_read_b128 v[216:219], v18 offset:0
    ds_read_b128 v[220:223], v19 offset:0
    ds_read_b128 v[224:227], v20 offset:0
    ds_read_b128 v[228:231], v21 offset:0
    ds_read_b128 v[232:235], v22 offset:0
    s_mov_b32 s69, s71
concat_heads__mha_block_cached__gqa_block_cached__near_ridge_kernel_a:
    s_waitcnt lgkmcnt(6)
    v_mfma_f32_32x32x16_bf16 v[160:175], v[208:211], v[128:131], 0
    ds_read_b128 v[236:239], v23 offset:0
    s_waitcnt lgkmcnt(6)
    v_mfma_f32_32x32x16_bf16 v[160:175], v[212:215], v[132:135], v[160:175]
    ds_read_b128 v[208:211], v16 offset:8192
    s_waitcnt lgkmcnt(6)
    v_mfma_f32_32x32x16_bf16 v[160:175], v[216:219], v[136:139], v[160:175]
    ds_read_b128 v[212:215], v17 offset:8192
    s_waitcnt lgkmcnt(6)
    v_mfma_f32_32x32x16_bf16 v[160:175], v[220:223], v[140:143], v[160:175]
    ds_read_b128 v[216:219], v18 offset:8192
    s_waitcnt lgkmcnt(6)
    v_mfma_f32_32x32x16_bf16 v[160:175], v[224:227], v[144:147], v[160:175]
    ds_read_b128 v[220:223], v19 offset:8192
    s_waitcnt lgkmcnt(6)
    v_mfma_f32_32x32x16_bf16 v[160:175], v[228:231], v[148:151], v[160:175]
    ds_read_b128 v[224:227], v20 offset:8192
    s_waitcnt lgkmcnt(6)
    v_mfma_f32_32x32x16_bf16 v[160:175], v[232:235], v[152:155], v[160:175]
    ds_read_b128 v[228:231], v21 offset:8192
    s_waitcnt lgkmcnt(6)
    v_mfma_f32_32x32x16_bf16 v[160:175], v[236:239], v[156:159], v[160:175]
    ds_read_b128 v[232:235], v22 offset:8192
    s_waitcnt lgkmcnt(6)
    v_mfma_f32_32x32x16_bf16 v[176:191], v[208:211], v[128:131], 0
    ds_read_b128 v[236:239], v23 offset:8192
    s_waitcnt lgkmcnt(6)
    v_mfma_f32_32x32x16_bf16 v[176:191], v[212:215], v[132:135], v[176:191]
    s_waitcnt lgkmcnt(5)
    v_mfma_f32_32x32x16_bf16 v[176:191], v[216:219], v[136:139], v[176:191]
    s_waitcnt lgkmcnt(4)
    v_mfma_f32_32x32x16_bf16 v[176:191], v[220:223], v[140:143], v[176:191]
    s_waitcnt lgkmcnt(3)
    v_mfma_f32_32x32x16_bf16 v[176:191], v[224:227], v[144:147], v[176:191]
    s_waitcnt lgkmcnt(2)
    v_mfma_f32_32x32x16_bf16 v[176:191], v[228:231], v[148:151], v[176:191]
    s_waitcnt lgkmcnt(1)
    v_mfma_f32_32x32x16_bf16 v[176:191], v[232:235], v[152:155], v[176:191]
    s_waitcnt lgkmcnt(0)
    v_mfma_f32_32x32x16_bf16 v[176:191], v[236:239], v[156:159], v[176:191]
    s_cmp_eq_u32 s69, 0
    s_cbranch_scc1 concat_heads__mha_block_cached__gqa_block_cached__near_ridge_kernel_a0
    s_barrier
    s_mov_b32 s69, 0
concat_heads__mha_block_cached__gqa_block_cached__near_ridge_kernel_a0:
    s_waitcnt vmcnt(8)
    s_barrier
    s_cmp_ge_u32 s55, 6
    s_cbranch_scc1 concat_heads__mha_block_cached__gqa_block_cached__near_ridge_kernel_wk
    s_add_u32 m0, s54, s64
    s_nop 0
    buffer_load_dwordx4 v6, s[40:43], s63 offen offset:0 nt lds
    buffer_load_dwordx4 v7, s[40:43], s63 offen offset:1024 nt lds
    buffer_load_dwordx4 v8, s[40:43], s63 offen offset:2048 nt lds
    buffer_load_dwordx4 v9, s[40:43], s63 offen offset:3072 nt lds
    s_add_u32 s54, s54, 32768
    s_cmp_eq_u32 s54, 163840
    s_cselect_b32 s54, 0, s54
    s_add_u32 m0, s54, s64
    s_nop 0
    buffer_load_dwordx4 v10, s[44:47], s63 offen offset:0 nt lds
    buffer_load_dwordx4 v10, s[44:47], s63 offen offset:1024 nt lds
    buffer_load_dwordx4 v10, s[44:47], s63 offen offset:2048 nt lds
    buffer_load_dwordx4 v10, s[44:47], s63 offen offset:3072 nt lds
    s_add_u32 s63, s63, 16384
    s_and_b32 s63, s63, 0x1ffff
concat_heads__mha_block_cached__gqa_block_cached__near_ridge_kernel_a1:
    s_add_u32 s54, s54, 32768
    s_cmp_eq_u32 s54, 163840
    s_cselect_b32 s54, 0, s54
    s_add_u32 s53, s54, 32768
    s_cmp_eq_u32 s53, 163840
    s_cselect_b32 s53, 0, s53
    v_add_u32 v32, s54, v14
    v_xor_b32 v33, 64, v32
    v_xor_b32 v34, 128, v32
    v_xor_b32 v35, 192, v32
    v_add_u32 v16, s53, v13
    v_xor_b32 v17, 32, v16
    v_xor_b32 v18, 64, v16
    v_xor_b32 v19, 96, v16
    v_xor_b32 v20, 128, v16
    v_xor_b32 v21, 160, v16
    v_xor_b32 v22, 192, v16
    v_xor_b32 v23, 224, v16
    v_max3_f32 v26, v160, v161, v162
    v_max3_f32 v27, v163, v164, v165
    v_max3_f32 v26, v26, v166, v167
    v_max3_f32 v27, v27, v168, v169
    v_max3_f32 v26, v26, v170, v171
    v_max3_f32 v27, v27, v172, v173
    v_max3_f32 v26, v26, v174, v175
    v_max3_f32 v27, v27, v176, v177
    v_max3_f32 v26, v26, v178, v179
    v_max3_f32 v27, v27, v180, v181
    v_max3_f32 v26, v26, v182, v183
    v_max3_f32 v27, v27, v184, v185
    v_max3_f32 v26, v26, v186, v187
    v_max3_f32 v27, v27, v188, v189
    v_max3_f32 v26, v26, v190, v191
    v_max_f32 v26, v26, v27
    v_mov_b32 v27, v26
    v_add_f32 v28, s60, v24
    s_nop 0
    v_permlane32_swap_b32 v26, v27
    v_max_f32 v26, v26, v27
    v_cmp_gt_f32 vcc, v26, v28
    s_cbranch_vccnz concat_heads__mha_block_cached__gqa_block_cached__near_ridge_kernel_resc
concat_heads__mha_block_cached__gqa_block_cached__near_ridge_kernel_a2:
    v_fma_f32 v160, v160, s59, v30
    v_fma_f32 v161, v161, s59, v30
    v_exp_f32 v160, v160
    v_fma_f32 v162, v162, s59, v30
    v_exp_f32 v161, v161
    v_add_f32 v25, v25, v160
    v_fma_f32 v163, v163, s59, v30
    v_exp_f32 v162, v162
    v_add_f32 v25, v25, v161
    v_cvt_pk_bf16_f32 v192, v160, v161
    v_fma_f32 v164, v164, s59, v30
    v_exp_f32 v163, v163
    v_add_f32 v25, v25, v162
    v_fma_f32 v165, v165, s59, v30
    v_exp_f32 v164, v164
    v_add_f32 v25, v25, v163
    v_cvt_pk_bf16_f32 v193, v162, v163
    v_fma_f32 v166, v166, s59, v30
    v_exp_f32 v165, v165
    v_add_f32 v25, v25, v164
    v_fma_f32 v167, v167, s59, v30
    v_exp_f32 v166, v166
    v_add_f32 v25, v25, v165
    v_cvt_pk_bf16_f32 v194, v164, v165
    v_fma_f32 v168, v168, s59, v30
    v_exp_f32 v167, v167
    v_add_f32 v25, v25, v166
    v_fma_f32 v169, v169, s59, v30
    v_exp_f32 v168, v168
    v_add_f32 v25, v25, v167
    v_cvt_pk_bf16_f32 v195, v166, v167
    v_fma_f32 v170, v170, s59, v30
    v_exp_f32 v169, v169
    v_add_f32 v25, v25, v168
    v_fma_f32 v171, v171, s59, v30
    v_exp_f32 v170, v170
    v_add_f32 v25, v25, v169
    v_cvt_pk_bf16_f32 v196, v168, v169
    v_fma_f32 v172, v172, s59, v30
    v_exp_f32 v171, v171
    v_add_f32 v25, v25, v170
    v_fma_f32 v173, v173, s59, v30
    v_exp_f32 v172, v172
    v_add_f32 v25, v25, v171
    v_cvt_pk_bf16_f32 v197, v170, v171
    v_fma_f32 v174, v174, s59, v30
    v_exp_f32 v173, v173
    v_add_f32 v25, v25, v172
    v_fma_f32 v175, v175, s59, v30
    v_exp_f32 v174, v174
    v_add_f32 v25, v25, v173
    v_cvt_pk_bf16_f32 v198, v172, v173
    v_fma_f32 v176, v176, s59, v30
    v_exp_f32 v175, v175
    v_add_f32 v25, v25, v174
    v_fma_f32 v177, v177, s59, v30
    v_exp_f32 v176, v176
    v_add_f32 v25, v25, v175
    v_cvt_pk_bf16_f32 v199, v174, v175
    v_fma_f32 v178, v178, s59, v30
    v_exp_f32 v177, v177
    v_add_f32 v25, v25, v176
    v_fma_f32 v179, v179, s59, v30
    v_exp_f32 v178, v178
    v_add_f32 v25, v25, v177
    v_cvt_pk_bf16_f32 v200, v176, v177
    v_fma_f32 v180, v180, s59, v30
    v_exp_f32 v179, v179
    v_add_f32 v25, v25, v178
    ds_read_b64_tr_b16 v[208:209], v32 offset:0
    ds_read_b64_tr_b16 v[210:211], v32 offset:2048
    v_fma_f32 v181, v181, s59, v30
    v_exp_f32 v180, v180
    v_add_f32 v25, v25, v179
    v_cvt_pk_bf16_f32 v201, v178, v179
    ds_read_b64_tr_b16 v[212:213], v33 offset:0
    ds_read_b64_tr_b16 v[214:215], v33 offset:2048
    v_fma_f32 v182, v182, s59, v30
    v_exp_f32 v181, v181
    v_add_f32 v25, v25, v180
    ds_read_b64_tr_b16 v[216:217], v34 offset:0
    ds_read_b64_tr_b16 v[218:219], v34 offset:2048
    v_fma_f32 v183, v183, s59, v30
    v_exp_f32 v182, v182
    v_add_f32 v25, v25, v181
    v_cvt_pk_bf16_f32 v202, v180, v181
    ds_read_b64_tr_b16 v[220:221], v35 offset:0
    ds_read_b64_tr_b16 v[222:223], v35 offset:2048
    v_fma_f32 v184, v184, s59, v30
    v_exp_f32 v183, v183
    v_add_f32 v25, v25, v182
    ds_read_b64_tr_b16 v[224:225], v32 offset:4096
    ds_read_b64_tr_b16 v[226:227], v32 offset:6144
    v_fma_f32 v185, v185, s59, v30
    v_exp_f32 v184, v184
    v_add_f32 v25, v25, v183
    v_cvt_pk_bf16_f32 v203, v182, v183
    ds_read_b64_tr_b16 v[228:229], v33 offset:4096
    ds_read_b64_tr_b16 v[230:231], v33 offset:6144
    v_fma_f32 v186, v186, s59, v30
    v_exp_f32 v185, v185
    v_add_f32 v25, v25, v184
    ds_read_b64_tr_b16 v[232:233], v34 offset:4096
    ds_read_b64_tr_b16 v[234:235], v34 offset:6144
    v_fma_f32 v187, v187, s59, v30
    v_exp_f32 v186, v186
    v_add_f32 v25, v25, v185
    v_cvt_pk_bf16_f32 v204, v184, v185
    v_fma_f32 v188, v188, s59, v30
    v_exp_f32 v187, v187
    v_add_f32 v25, v25, v186
    v_fma_f32 v189, v189, s59, v30
    v_exp_f32 v188, v188
    v_add_f32 v25, v25, v187
    v_cvt_pk_bf16_f32 v205, v186, v187
    v_fma_f32 v190, v190, s59, v30
    v_exp_f32 v189, v189
    v_add_f32 v25, v25, v188
    v_fma_f32 v191, v191, s59, v30
    v_exp_f32 v190, v190
    v_add_f32 v25, v25, v189
    v_cvt_pk_bf16_f32 v206, v188, v189
    v_exp_f32 v191, v191
    v_add_f32 v25, v25, v190
    v_add_f32 v25, v25, v191
    v_cvt_pk_bf16_f32 v207, v190, v191
    s_waitcnt vmcnt(12)
    s_barrier
    s_waitcnt lgkmcnt(12)
    v_mfma_f32_32x32x16_bf16 v[64:79], v[208:211], v[192:195], v[64:79]
    ds_read_b64_tr_b16 v[236:237], v35 offset:4096
    ds_read_b64_tr_b16 v[238:239], v35 offset:6144
    s_waitcnt lgkmcnt(12)
    v_mfma_f32_32x32x16_bf16 v[80:95], v[212:215], v[192:195], v[80:95]
    ds_read_b64_tr_b16 v[208:209], v32 offset:8192
    ds_read_b64_tr_b16 v[210:211], v32 offset:10240
    s_waitcnt lgkmcnt(12)
    v_mfma_f32_32x32x16_bf16 v[96:111], v[216:219], v[192:195], v[96:111]
    ds_read_b64_tr_b16 v[212:213], v33 offset:8192
    ds_read_b64_tr_b16 v[214:215], v33 offset:10240
    s_waitcnt lgkmcnt(12)
    v_mfma_f32_32x32x16_bf16 v[112:127], v[220:223], v[192:195], v[112:127]
    ds_read_b64_tr_b16 v[216:217], v34 offset:8192
    ds_read_b64_tr_b16 v[218:219], v34 offset:10240
    s_waitcnt lgkmcnt(12)
    v_mfma_f32_32x32x16_bf16 v[64:79], v[224:227], v[196:199], v[64:79]
    ds_read_b64_tr_b16 v[220:221], v35 offset:8192
    ds_read_b64_tr_b16 v[222:223], v35 offset:10240
    s_waitcnt lgkmcnt(12)
    v_mfma_f32_32x32x16_bf16 v[80:95], v[228:231], v[196:199], v[80:95]
    ds_read_b64_tr_b16 v[224:225], v32 offset:12288
    ds_read_b64_tr_b16 v[226:227], v32 offset:14336
    s_waitcnt lgkmcnt(12)
    v_mfma_f32_32x32x16_bf16 v[96:111], v[232:235], v[196:199], v[96:111]
    ds_read_b64_tr_b16 v[228:229], v33 offset:12288
    ds_read_b64_tr_b16 v[230:231], v33 offset:14336
    s_waitcnt lgkmcnt(12)
    v_mfma_f32_32x32x16_bf16 v[112:127], v[236:239], v[196:199], v[112:127]
    ds_read_b64_tr_b16 v[232:233], v34 offset:12288
    ds_read_b64_tr_b16 v[234:235], v34 offset:14336
    s_waitcnt lgkmcnt(12)
    v_mfma_f32_32x32x16_bf16 v[64:79], v[208:211], v[200:203], v[64:79]
    ds_read_b64_tr_b16 v[236:237], v35 offset:12288
    ds_read_b64_tr_b16 v[238:239], v35 offset:14336
    s_waitcnt lgkmcnt(12)
    v_mfma_f32_32x32x16_bf16 v[80:95], v[212:215], v[200:203], v[80:95]
    ds_read_b128 v[208:211], v16 offset:0
    s_waitcnt lgkmcnt(11)
    v_mfma_f32_32x32x16_bf16 v[96:111], v[216:219], v[200:203], v[96:111]
    ds_read_b128 v[212:215], v17 offset:0
    s_waitcnt lgkmcnt(10)
    v_mfma_f32_32x32x16_bf16 v[112:127], v[220:223], v[200:203], v[112:127]
    ds_read_b128 v[216:219], v18 offset:0
    s_waitcnt lgkmcnt(9)
    v_mfma_f32_32x32x16_bf16 v[64:79], v[224:227], v[204:207], v[64:79]
    ds_read_b128 v[220:223], v19 offset:0
    s_waitcnt lgkmcnt(8)
    v_mfma_f32_32x32x16_bf16 v[80:95], v[228:231], v[204:207], v[80:95]
    ds_read_b128 v[224:227], v20 offset:0
    s_waitcnt lgkmcnt(7)
    v_mfma_f32_32x32x16_bf16 v[96:111], v[232:235], v[204:207], v[96:111]
    ds_read_b128 v[228:231], v21 offset:0
    s_waitcnt lgkmcnt(6)
    v_mfma_f32_32x32x16_bf16 v[112:127], v[236:239], v[204:207], v[112:127]
    ds_read_b128 v[232:235], v22 offset:0
    s_add_u32 s55, s55, 1
    s_cmp_lt_u32 s55, 8
    s_cbranch_scc1 concat_heads__mha_block_cached__gqa_block_cached__near_ridge_kernel_a
    v_mov_b32 v26, v25
    s_nop 1
    v_permlane32_swap_b32 v26, v25
    v_add_f32 v25, v25, v26
    v_rcp_f32 v25, v25
    s_nop 7
    s_and_b32 s65, s28, 7
    s_lshl_b32 s65, s65, 13
    s_add_u32 s66, s65, 4096
    s_waitcnt vmcnt(8)
    v_mul_f32 v64, v64, v25
    v_mul_f32 v65, v65, v25
    v_mul_f32 v66, v66, v25
    v_mul_f32 v67, v67, v25
    v_mul_f32 v68, v68, v25
    v_mul_f32 v69, v69, v25
    v_mul_f32 v70, v70, v25
    v_mul_f32 v71, v71, v25
    v_cvt_pk_bf16_f32 v128, v64, v65
    v_cvt_pk_bf16_f32 v129, v66, v67
    v_cvt_pk_bf16_f32 v130, v68, v69
    v_cvt_pk_bf16_f32 v131, v70, v71
    buffer_store_dwordx4 v[128:131], v31, s[48:51], s65 offen offset:0 sc1
    v_mul_f32 v72, v72, v25
    v_mul_f32 v73, v73, v25
    v_mul_f32 v74, v74, v25
    v_mul_f32 v75, v75, v25
    v_mul_f32 v76, v76, v25
    v_mul_f32 v77, v77, v25
    v_mul_f32 v78, v78, v25
    v_mul_f32 v79, v79, v25
    v_cvt_pk_bf16_f32 v132, v72, v73
    v_cvt_pk_bf16_f32 v133, v74, v75
    v_cvt_pk_bf16_f32 v134, v76, v77
    v_cvt_pk_bf16_f32 v135, v78, v79
    buffer_store_dwordx4 v[132:135], v31, s[48:51], s65 offen offset:1024 sc1
    v_mul_f32 v80, v80, v25
    v_mul_f32 v81, v81, v25
    v_mul_f32 v82, v82, v25
    v_mul_f32 v83, v83, v25
    v_mul_f32 v84, v84, v25
    v_mul_f32 v85, v85, v25
    v_mul_f32 v86, v86, v25
    v_mul_f32 v87, v87, v25
    v_cvt_pk_bf16_f32 v136, v80, v81
    v_cvt_pk_bf16_f32 v137, v82, v83
    v_cvt_pk_bf16_f32 v138, v84, v85
    v_cvt_pk_bf16_f32 v139, v86, v87
    buffer_store_dwordx4 v[136:139], v31, s[48:51], s65 offen offset:2048 sc1
    v_mul_f32 v88, v88, v25
    v_mul_f32 v89, v89, v25
    v_mul_f32 v90, v90, v25
    v_mul_f32 v91, v91, v25
    v_mul_f32 v92, v92, v25
    v_mul_f32 v93, v93, v25
    v_mul_f32 v94, v94, v25
    v_mul_f32 v95, v95, v25
    v_cvt_pk_bf16_f32 v140, v88, v89
    v_cvt_pk_bf16_f32 v141, v90, v91
    v_cvt_pk_bf16_f32 v142, v92, v93
    v_cvt_pk_bf16_f32 v143, v94, v95
    buffer_store_dwordx4 v[140:143], v31, s[48:51], s65 offen offset:3072 sc1
    v_mul_f32 v96, v96, v25
    v_mul_f32 v97, v97, v25
    v_mul_f32 v98, v98, v25
    v_mul_f32 v99, v99, v25
    v_mul_f32 v100, v100, v25
    v_mul_f32 v101, v101, v25
    v_mul_f32 v102, v102, v25
    v_mul_f32 v103, v103, v25
    v_cvt_pk_bf16_f32 v144, v96, v97
    v_cvt_pk_bf16_f32 v145, v98, v99
    v_cvt_pk_bf16_f32 v146, v100, v101
    v_cvt_pk_bf16_f32 v147, v102, v103
    buffer_store_dwordx4 v[144:147], v31, s[48:51], s66 offen offset:0 sc1
    v_mul_f32 v104, v104, v25
    v_mul_f32 v105, v105, v25
    v_mul_f32 v106, v106, v25
    v_mul_f32 v107, v107, v25
    v_mul_f32 v108, v108, v25
    v_mul_f32 v109, v109, v25
    v_mul_f32 v110, v110, v25
    v_mul_f32 v111, v111, v25
    v_cvt_pk_bf16_f32 v148, v104, v105
    v_cvt_pk_bf16_f32 v149, v106, v107
    v_cvt_pk_bf16_f32 v150, v108, v109
    v_cvt_pk_bf16_f32 v151, v110, v111
    buffer_store_dwordx4 v[148:151], v31, s[48:51], s66 offen offset:1024 sc1
    v_mul_f32 v112, v112, v25
    v_mul_f32 v113, v113, v25
    v_mul_f32 v114, v114, v25
    v_mul_f32 v115, v115, v25
    v_mul_f32 v116, v116, v25
    v_mul_f32 v117, v117, v25
    v_mul_f32 v118, v118, v25
    v_mul_f32 v119, v119, v25
    v_cvt_pk_bf16_f32 v152, v112, v113
    v_cvt_pk_bf16_f32 v153, v114, v115
    v_cvt_pk_bf16_f32 v154, v116, v117
    v_cvt_pk_bf16_f32 v155, v118, v119
    buffer_store_dwordx4 v[152:155], v31, s[48:51], s66 offen offset:2048 sc1
    v_mul_f32 v120, v120, v25
    v_mul_f32 v121, v121, v25
    v_mul_f32 v122, v122, v25
    v_mul_f32 v123, v123, v25
    v_mul_f32 v124, v124, v25
    v_mul_f32 v125, v125, v25
    v_mul_f32 v126, v126, v25
    v_mul_f32 v127, v127, v25
    v_cvt_pk_bf16_f32 v156, v120, v121
    v_cvt_pk_bf16_f32 v157, v122, v123
    v_cvt_pk_bf16_f32 v158, v124, v125
    v_cvt_pk_bf16_f32 v159, v126, v127
    buffer_store_dwordx4 v[156:159], v31, s[48:51], s66 offen offset:3072 sc1
    s_lshl_b32 s57, s30, 6
    s_lshl_b32 s58, s71, 5
    s_or_b32 s57, s57, s58
    v_xor_b32 v14, s57, v14
    s_waitcnt vmcnt(20)
    s_barrier
    v_add_u32 v16, 32768, v14
    v_xor_b32 v17, 64, v16
    v_xor_b32 v18, 128, v16
    v_xor_b32 v19, 192, v16
    ds_read_b64_tr_b16 v[208:209], v16 offset:0
    ds_read_b64_tr_b16 v[210:211], v16 offset:2048
    ds_read_b64_tr_b16 v[212:213], v17 offset:0
    ds_read_b64_tr_b16 v[214:215], v17 offset:2048
    ds_read_b64_tr_b16 v[216:217], v18 offset:0
    ds_read_b64_tr_b16 v[218:219], v18 offset:2048
    ds_read_b64_tr_b16 v[220:221], v19 offset:0
    ds_read_b64_tr_b16 v[222:223], v19 offset:2048
    ds_read_b64_tr_b16 v[224:225], v16 offset:4096
    ds_read_b64_tr_b16 v[226:227], v16 offset:6144
    ds_read_b64_tr_b16 v[228:229], v17 offset:4096
    ds_read_b64_tr_b16 v[230:231], v17 offset:6144
    ds_read_b64_tr_b16 v[232:233], v18 offset:4096
    ds_read_b64_tr_b16 v[234:235], v18 offset:6144
    s_add_u32 m0, 0, s64
    s_and_b32 s57, s68, 6
    s_lshl_b32 s57, s57, 17
    s_and_b32 s58, s68, 1
    s_lshl_b32 s58, s58, 16
    s_add_u32 s57, s57, s58
    s_add_u32 s57, s57, s79
    s_add_u32 s68, s68, 1
    buffer_load_dwordx4 v240, s[32:35], s57 offen offset:0 lds
    buffer_load_dwordx4 v241, s[32:35], s57 offen offset:1024 lds
    buffer_load_dwordx4 v242, s[32:35], s57 offen offset:2048 lds
    buffer_load_dwordx4 v243, s[32:35], s57 offen offset:3072 lds
    s_waitcnt lgkmcnt(12)
    v_mfma_f32_32x32x16_bf16 v[64:79], v[208:211], v[128:131], 0
    ds_read_b64_tr_b16 v[236:237], v19 offset:4096
    ds_read_b64_tr_b16 v[238:239], v19 offset:6144
    s_waitcnt lgkmcnt(12)
    v_mfma_f32_32x32x16_bf16 v[80:95], v[212:215], v[128:131], 0
    ds_read_b64_tr_b16 v[208:209], v16 offset:8192
    ds_read_b64_tr_b16 v[210:211], v16 offset:10240
    s_waitcnt lgkmcnt(12)
    v_mfma_f32_32x32x16_bf16 v[96:111], v[216:219], v[128:131], 0
    ds_read_b64_tr_b16 v[212:213], v17 offset:8192
    ds_read_b64_tr_b16 v[214:215], v17 offset:10240
    s_waitcnt lgkmcnt(12)
    v_mfma_f32_32x32x16_bf16 v[112:127], v[220:223], v[128:131], 0
    ds_read_b64_tr_b16 v[216:217], v18 offset:8192
    ds_read_b64_tr_b16 v[218:219], v18 offset:10240
    s_waitcnt lgkmcnt(12)
    v_mfma_f32_32x32x16_bf16 v[64:79], v[224:227], v[132:135], v[64:79]
    ds_read_b64_tr_b16 v[220:221], v19 offset:8192
    ds_read_b64_tr_b16 v[222:223], v19 offset:10240
    s_waitcnt lgkmcnt(12)
    v_mfma_f32_32x32x16_bf16 v[80:95], v[228:231], v[132:135], v[80:95]
    ds_read_b64_tr_b16 v[224:225], v16 offset:12288
    ds_read_b64_tr_b16 v[226:227], v16 offset:14336
    s_waitcnt lgkmcnt(12)
    v_mfma_f32_32x32x16_bf16 v[96:111], v[232:235], v[132:135], v[96:111]
    ds_read_b64_tr_b16 v[228:229], v17 offset:12288
    ds_read_b64_tr_b16 v[230:231], v17 offset:14336
    s_waitcnt lgkmcnt(12)
    v_mfma_f32_32x32x16_bf16 v[112:127], v[236:239], v[132:135], v[112:127]
    ds_read_b64_tr_b16 v[232:233], v18 offset:12288
    ds_read_b64_tr_b16 v[234:235], v18 offset:14336
    s_waitcnt lgkmcnt(12)
    v_mfma_f32_32x32x16_bf16 v[64:79], v[208:211], v[136:139], v[64:79]
    ds_read_b64_tr_b16 v[236:237], v19 offset:12288
    ds_read_b64_tr_b16 v[238:239], v19 offset:14336
    s_waitcnt lgkmcnt(12)
    v_mfma_f32_32x32x16_bf16 v[80:95], v[212:215], v[136:139], v[80:95]
    s_waitcnt lgkmcnt(10)
    v_mfma_f32_32x32x16_bf16 v[96:111], v[216:219], v[136:139], v[96:111]
    s_waitcnt lgkmcnt(8)
    v_mfma_f32_32x32x16_bf16 v[112:127], v[220:223], v[136:139], v[112:127]
    s_waitcnt lgkmcnt(6)
    v_mfma_f32_32x32x16_bf16 v[64:79], v[224:227], v[140:143], v[64:79]
    s_waitcnt lgkmcnt(4)
    v_mfma_f32_32x32x16_bf16 v[80:95], v[228:231], v[140:143], v[80:95]
    s_waitcnt lgkmcnt(2)
    v_mfma_f32_32x32x16_bf16 v[96:111], v[232:235], v[140:143], v[96:111]
    s_waitcnt lgkmcnt(0)
    v_mfma_f32_32x32x16_bf16 v[112:127], v[236:239], v[140:143], v[112:127]
    s_waitcnt vmcnt(4)
    s_mov_b64 exec, 1
    buffer_store_dword v4, off, s[80:83], s78 offset:0 sc1
    s_mov_b64 exec, -1
    s_barrier
    v_add_u32 v20, 65536, v14
    v_xor_b32 v21, 64, v20
    v_xor_b32 v22, 128, v20
    v_xor_b32 v23, 192, v20
    ds_read_b64_tr_b16 v[208:209], v20 offset:0
    ds_read_b64_tr_b16 v[210:211], v20 offset:2048
    ds_read_b64_tr_b16 v[212:213], v21 offset:0
    ds_read_b64_tr_b16 v[214:215], v21 offset:2048
    ds_read_b64_tr_b16 v[216:217], v22 offset:0
    ds_read_b64_tr_b16 v[218:219], v22 offset:2048
    ds_read_b64_tr_b16 v[220:221], v23 offset:0
    ds_read_b64_tr_b16 v[222:223], v23 offset:2048
    ds_read_b64_tr_b16 v[224:225], v20 offset:4096
    ds_read_b64_tr_b16 v[226:227], v20 offset:6144
    ds_read_b64_tr_b16 v[228:229], v21 offset:4096
    ds_read_b64_tr_b16 v[230:231], v21 offset:6144
    ds_read_b64_tr_b16 v[232:233], v22 offset:4096
    ds_read_b64_tr_b16 v[234:235], v22 offset:6144
    s_add_u32 m0, 32768, s64
    s_and_b32 s57, s68, 6
    s_lshl_b32 s57, s57, 17
    s_and_b32 s58, s68, 1
    s_lshl_b32 s58, s58, 16
    s_add_u32 s57, s57, s58
    s_add_u32 s57, s57, s79
    s_add_u32 s68, s68, 1
    buffer_load_dwordx4 v240, s[32:35], s57 offen offset:0 lds
    buffer_load_dwordx4 v241, s[32:35], s57 offen offset:1024 lds
    buffer_load_dwordx4 v242, s[32:35], s57 offen offset:2048 lds
    buffer_load_dwordx4 v243, s[32:35], s57 offen offset:3072 lds
    s_waitcnt lgkmcnt(12)
    v_mfma_f32_32x32x16_bf16 v[64:79], v[208:211], v[144:147], v[64:79]
    ds_read_b64_tr_b16 v[236:237], v23 offset:4096
    ds_read_b64_tr_b16 v[238:239], v23 offset:6144
    s_waitcnt lgkmcnt(12)
    v_mfma_f32_32x32x16_bf16 v[80:95], v[212:215], v[144:147], v[80:95]
    ds_read_b64_tr_b16 v[208:209], v20 offset:8192
    ds_read_b64_tr_b16 v[210:211], v20 offset:10240
    s_waitcnt lgkmcnt(12)
    v_mfma_f32_32x32x16_bf16 v[96:111], v[216:219], v[144:147], v[96:111]
    ds_read_b64_tr_b16 v[212:213], v21 offset:8192
    ds_read_b64_tr_b16 v[214:215], v21 offset:10240
    s_waitcnt lgkmcnt(12)
    v_mfma_f32_32x32x16_bf16 v[112:127], v[220:223], v[144:147], v[112:127]
    ds_read_b64_tr_b16 v[216:217], v22 offset:8192
    ds_read_b64_tr_b16 v[218:219], v22 offset:10240
    s_waitcnt lgkmcnt(12)
    v_mfma_f32_32x32x16_bf16 v[64:79], v[224:227], v[148:151], v[64:79]
    ds_read_b64_tr_b16 v[220:221], v23 offset:8192
    ds_read_b64_tr_b16 v[222:223], v23 offset:10240
    s_waitcnt lgkmcnt(12)
    v_mfma_f32_32x32x16_bf16 v[80:95], v[228:231], v[148:151], v[80:95]
    ds_read_b64_tr_b16 v[224:225], v20 offset:12288
    ds_read_b64_tr_b16 v[226:227], v20 offset:14336
    s_waitcnt lgkmcnt(12)
    v_mfma_f32_32x32x16_bf16 v[96:111], v[232:235], v[148:151], v[96:111]
    ds_read_b64_tr_b16 v[228:229], v21 offset:12288
    ds_read_b64_tr_b16 v[230:231], v21 offset:14336
    s_waitcnt lgkmcnt(12)
    v_mfma_f32_32x32x16_bf16 v[112:127], v[236:239], v[148:151], v[112:127]
    ds_read_b64_tr_b16 v[232:233], v22 offset:12288
    ds_read_b64_tr_b16 v[234:235], v22 offset:14336
    s_waitcnt lgkmcnt(12)
    v_mfma_f32_32x32x16_bf16 v[64:79], v[208:211], v[152:155], v[64:79]
    ds_read_b64_tr_b16 v[236:237], v23 offset:12288
    ds_read_b64_tr_b16 v[238:239], v23 offset:14336
    s_waitcnt lgkmcnt(12)
    v_mfma_f32_32x32x16_bf16 v[80:95], v[212:215], v[152:155], v[80:95]
    s_waitcnt lgkmcnt(10)
    v_mfma_f32_32x32x16_bf16 v[96:111], v[216:219], v[152:155], v[96:111]
    s_waitcnt lgkmcnt(8)
    v_mfma_f32_32x32x16_bf16 v[112:127], v[220:223], v[152:155], v[112:127]
    s_waitcnt lgkmcnt(6)
    v_mfma_f32_32x32x16_bf16 v[64:79], v[224:227], v[156:159], v[64:79]
    s_waitcnt lgkmcnt(4)
    v_mfma_f32_32x32x16_bf16 v[80:95], v[228:231], v[156:159], v[80:95]
    s_waitcnt lgkmcnt(2)
    v_mfma_f32_32x32x16_bf16 v[96:111], v[232:235], v[156:159], v[96:111]
    s_waitcnt lgkmcnt(0)
    v_mfma_f32_32x32x16_bf16 v[112:127], v[236:239], v[156:159], v[112:127]
    v_add_u32 v16, 98304, v14
    v_xor_b32 v17, 64, v16
    v_xor_b32 v18, 128, v16
    v_xor_b32 v19, 192, v16
    ds_read_b64_tr_b16 v[208:209], v16 offset:0
    ds_read_b64_tr_b16 v[210:211], v16 offset:2048
    ds_read_b64_tr_b16 v[212:213], v17 offset:0
    ds_read_b64_tr_b16 v[214:215], v17 offset:2048
    ds_read_b64_tr_b16 v[216:217], v18 offset:0
    ds_read_b64_tr_b16 v[218:219], v18 offset:2048
    ds_read_b64_tr_b16 v[220:221], v19 offset:0
    ds_read_b64_tr_b16 v[222:223], v19 offset:2048
    ds_read_b64_tr_b16 v[224:225], v16 offset:4096
    ds_read_b64_tr_b16 v[226:227], v16 offset:6144
    ds_read_b64_tr_b16 v[228:229], v17 offset:4096
    ds_read_b64_tr_b16 v[230:231], v17 offset:6144
    ds_read_b64_tr_b16 v[232:233], v18 offset:4096
    ds_read_b64_tr_b16 v[234:235], v18 offset:6144
    s_cmp_lg_u32 s71, 0
    s_cbranch_scc1 concat_heads__mha_block_cached__gqa_block_cached__near_ridge_kernel_c4
    s_barrier
concat_heads__mha_block_cached__gqa_block_cached__near_ridge_kernel_c4:
    s_mov_b32 s58, 0
    s_branch concat_heads__mha_block_cached__gqa_block_cached__near_ridge_kernel_p0c
concat_heads__mha_block_cached__gqa_block_cached__near_ridge_kernel_p0:
    buffer_load_dword v50, off, s[16:19], 0 sc1
    s_waitcnt vmcnt(0)
concat_heads__mha_block_cached__gqa_block_cached__near_ridge_kernel_p0c:
    v_cmp_gt_u32 vcc, 16, v50
    s_add_u32 s58, s58, 1
    s_cmp_ge_u32 s58, 0x80000
    s_cbranch_scc1 concat_heads__mha_block_cached__gqa_block_cached__near_ridge_kernel_p0x
    s_cbranch_vccnz concat_heads__mha_block_cached__gqa_block_cached__near_ridge_kernel_p0
concat_heads__mha_block_cached__gqa_block_cached__near_ridge_kernel_p0x:
    s_mov_b32 s58, 0
concat_heads__mha_block_cached__gqa_block_cached__near_ridge_kernel_p1:
    buffer_load_dword v15, v2, s[80:83], s67 offen sc1
    s_waitcnt vmcnt(0)
concat_heads__mha_block_cached__gqa_block_cached__near_ridge_kernel_p1c:
    v_cmp_ne_u32 vcc, 1, v15
    s_add_u32 s58, s58, 1
    s_cmp_ge_u32 s58, 0x80000
    s_cbranch_scc1 concat_heads__mha_block_cached__gqa_block_cached__near_ridge_kernel_p1x
    s_cbranch_vccnz concat_heads__mha_block_cached__gqa_block_cached__near_ridge_kernel_p1
concat_heads__mha_block_cached__gqa_block_cached__near_ridge_kernel_p1x:
    s_add_u32 s65, s29, 1
    s_and_b32 s65, s65, 3
    s_lshl1_add_u32 s65, s65, s71
    s_lshl_b32 s65, s65, 13
    s_add_u32 s66, s65, 4096
    buffer_load_dwordx4 v[160:163], v31, s[48:51], s65 offen offset:0 sc1
    buffer_load_dwordx4 v[164:167], v31, s[48:51], s65 offen offset:1024 sc1
    buffer_load_dwordx4 v[168:171], v31, s[48:51], s65 offen offset:2048 sc1
    buffer_load_dwordx4 v[172:175], v31, s[48:51], s65 offen offset:3072 sc1
    buffer_load_dwordx4 v[176:179], v31, s[48:51], s66 offen offset:0 sc1
    buffer_load_dwordx4 v[180:183], v31, s[48:51], s66 offen offset:1024 sc1
    buffer_load_dwordx4 v[184:187], v31, s[48:51], s66 offen offset:2048 sc1
    buffer_load_dwordx4 v[188:191], v31, s[48:51], s66 offen offset:3072 sc1
    s_add_u32 s65, s29, 2
    s_and_b32 s65, s65, 3
    s_lshl1_add_u32 s65, s65, s71
    s_lshl_b32 s65, s65, 13
    s_add_u32 s66, s65, 4096
    buffer_load_dwordx4 v[32:35], v31, s[48:51], s65 offen offset:0 sc1
    buffer_load_dwordx4 v[36:39], v31, s[48:51], s65 offen offset:1024 sc1
    buffer_load_dwordx4 v[40:43], v31, s[48:51], s65 offen offset:2048 sc1
    buffer_load_dwordx4 v[44:47], v31, s[48:51], s65 offen offset:3072 sc1
    buffer_load_dwordx4 v[48:51], v31, s[48:51], s66 offen offset:0 sc1
    buffer_load_dwordx4 v[52:55], v31, s[48:51], s66 offen offset:1024 sc1
    buffer_load_dwordx4 v[56:59], v31, s[48:51], s66 offen offset:2048 sc1
    buffer_load_dwordx4 v[60:63], v31, s[48:51], s66 offen offset:3072 sc1
    s_add_u32 s65, s29, 3
    s_and_b32 s65, s65, 3
    s_lshl1_add_u32 s65, s65, s71
    s_lshl_b32 s65, s65, 13
    s_add_u32 s66, s65, 4096
    buffer_load_dwordx4 v[128:131], v31, s[48:51], s65 offen offset:0 sc1
    buffer_load_dwordx4 v[132:135], v31, s[48:51], s65 offen offset:1024 sc1
    buffer_load_dwordx4 v[136:139], v31, s[48:51], s65 offen offset:2048 sc1
    buffer_load_dwordx4 v[140:143], v31, s[48:51], s65 offen offset:3072 sc1
    buffer_load_dwordx4 v[144:147], v31, s[48:51], s66 offen offset:0 sc1
    buffer_load_dwordx4 v[148:151], v31, s[48:51], s66 offen offset:1024 sc1
    buffer_load_dwordx4 v[152:155], v31, s[48:51], s66 offen offset:2048 sc1
    buffer_load_dwordx4 v[156:159], v31, s[48:51], s66 offen offset:3072 sc1
    s_barrier
    s_add_u32 m0, 65536, s64
    s_and_b32 s57, s68, 6
    s_lshl_b32 s57, s57, 17
    s_and_b32 s58, s68, 1
    s_lshl_b32 s58, s58, 16
    s_add_u32 s57, s57, s58
    s_add_u32 s57, s57, s79
    s_add_u32 s68, s68, 1
    buffer_load_dwordx4 v240, s[32:35], s57 offen offset:0 lds
    buffer_load_dwordx4 v241, s[32:35], s57 offen offset:1024 lds
    buffer_load_dwordx4 v242, s[32:35], s57 offen offset:2048 lds
    buffer_load_dwordx4 v243, s[32:35], s57 offen offset:3072 lds
    s_waitcnt vmcnt(24)
    s_waitcnt lgkmcnt(12)
    v_mfma_f32_32x32x16_bf16 v[64:79], v[208:211], v[160:163], v[64:79]
    ds_read_b64_tr_b16 v[236:237], v19 offset:4096
    ds_read_b64_tr_b16 v[238:239], v19 offset:6144
    s_waitcnt lgkmcnt(12)
    v_mfma_f32_32x32x16_bf16 v[80:95], v[212:215], v[160:163], v[80:95]
    ds_read_b64_tr_b16 v[208:209], v16 offset:8192
    ds_read_b64_tr_b16 v[210:211], v16 offset:10240
    s_waitcnt lgkmcnt(12)
    v_mfma_f32_32x32x16_bf16 v[96:111], v[216:219], v[160:163], v[96:111]
    ds_read_b64_tr_b16 v[212:213], v17 offset:8192
    ds_read_b64_tr_b16 v[214:215], v17 offset:10240
    s_waitcnt lgkmcnt(12)
    v_mfma_f32_32x32x16_bf16 v[112:127], v[220:223], v[160:163], v[112:127]
    ds_read_b64_tr_b16 v[216:217], v18 offset:8192
    ds_read_b64_tr_b16 v[218:219], v18 offset:10240
    s_waitcnt lgkmcnt(12)
    v_mfma_f32_32x32x16_bf16 v[64:79], v[224:227], v[164:167], v[64:79]
    ds_read_b64_tr_b16 v[220:221], v19 offset:8192
    ds_read_b64_tr_b16 v[222:223], v19 offset:10240
    s_waitcnt lgkmcnt(12)
    v_mfma_f32_32x32x16_bf16 v[80:95], v[228:231], v[164:167], v[80:95]
    ds_read_b64_tr_b16 v[224:225], v16 offset:12288
    ds_read_b64_tr_b16 v[226:227], v16 offset:14336
    s_waitcnt lgkmcnt(12)
    v_mfma_f32_32x32x16_bf16 v[96:111], v[232:235], v[164:167], v[96:111]
    ds_read_b64_tr_b16 v[228:229], v17 offset:12288
    ds_read_b64_tr_b16 v[230:231], v17 offset:14336
    s_waitcnt lgkmcnt(12)
    v_mfma_f32_32x32x16_bf16 v[112:127], v[236:239], v[164:167], v[112:127]
    ds_read_b64_tr_b16 v[232:233], v18 offset:12288
    ds_read_b64_tr_b16 v[234:235], v18 offset:14336
    s_waitcnt lgkmcnt(12)
    v_mfma_f32_32x32x16_bf16 v[64:79], v[208:211], v[168:171], v[64:79]
    ds_read_b64_tr_b16 v[236:237], v19 offset:12288
    ds_read_b64_tr_b16 v[238:239], v19 offset:14336
    s_waitcnt lgkmcnt(12)
    v_mfma_f32_32x32x16_bf16 v[80:95], v[212:215], v[168:171], v[80:95]
    v_add_u32 v20, 131072, v14
    v_xor_b32 v21, 64, v20
    v_xor_b32 v22, 128, v20
    v_xor_b32 v23, 192, v20
    ds_read_b64_tr_b16 v[208:209], v20 offset:0
    ds_read_b64_tr_b16 v[210:211], v20 offset:2048
    s_waitcnt lgkmcnt(12)
    v_mfma_f32_32x32x16_bf16 v[96:111], v[216:219], v[168:171], v[96:111]
    ds_read_b64_tr_b16 v[212:213], v21 offset:0
    ds_read_b64_tr_b16 v[214:215], v21 offset:2048
    s_waitcnt lgkmcnt(12)
    v_mfma_f32_32x32x16_bf16 v[112:127], v[220:223], v[168:171], v[112:127]
    ds_read_b64_tr_b16 v[216:217], v22 offset:0
    ds_read_b64_tr_b16 v[218:219], v22 offset:2048
    s_waitcnt lgkmcnt(12)
    v_mfma_f32_32x32x16_bf16 v[64:79], v[224:227], v[172:175], v[64:79]
    ds_read_b64_tr_b16 v[220:221], v23 offset:0
    ds_read_b64_tr_b16 v[222:223], v23 offset:2048
    s_waitcnt lgkmcnt(12)
    v_mfma_f32_32x32x16_bf16 v[80:95], v[228:231], v[172:175], v[80:95]
    ds_read_b64_tr_b16 v[224:225], v20 offset:4096
    ds_read_b64_tr_b16 v[226:227], v20 offset:6144
    s_waitcnt lgkmcnt(12)
    v_mfma_f32_32x32x16_bf16 v[96:111], v[232:235], v[172:175], v[96:111]
    ds_read_b64_tr_b16 v[228:229], v21 offset:4096
    ds_read_b64_tr_b16 v[230:231], v21 offset:6144
    s_waitcnt lgkmcnt(12)
    v_mfma_f32_32x32x16_bf16 v[112:127], v[236:239], v[172:175], v[112:127]
    ds_read_b64_tr_b16 v[232:233], v22 offset:4096
    ds_read_b64_tr_b16 v[234:235], v22 offset:6144
    s_barrier
    s_add_u32 m0, 98304, s64
    s_and_b32 s57, s68, 6
    s_lshl_b32 s57, s57, 17
    s_and_b32 s58, s68, 1
    s_lshl_b32 s58, s58, 16
    s_add_u32 s57, s57, s58
    s_add_u32 s57, s57, s79
    s_add_u32 s68, s68, 1
    buffer_load_dwordx4 v240, s[32:35], s57 offen offset:0 lds
    buffer_load_dwordx4 v241, s[32:35], s57 offen offset:1024 lds
    buffer_load_dwordx4 v242, s[32:35], s57 offen offset:2048 lds
    buffer_load_dwordx4 v243, s[32:35], s57 offen offset:3072 lds
    s_waitcnt vmcnt(24)
    s_waitcnt lgkmcnt(12)
    v_mfma_f32_32x32x16_bf16 v[64:79], v[208:211], v[176:179], v[64:79]
    ds_read_b64_tr_b16 v[236:237], v23 offset:4096
    ds_read_b64_tr_b16 v[238:239], v23 offset:6144
    s_waitcnt lgkmcnt(12)
    v_mfma_f32_32x32x16_bf16 v[80:95], v[212:215], v[176:179], v[80:95]
    ds_read_b64_tr_b16 v[208:209], v20 offset:8192
    ds_read_b64_tr_b16 v[210:211], v20 offset:10240
    s_waitcnt lgkmcnt(12)
    v_mfma_f32_32x32x16_bf16 v[96:111], v[216:219], v[176:179], v[96:111]
    ds_read_b64_tr_b16 v[212:213], v21 offset:8192
    ds_read_b64_tr_b16 v[214:215], v21 offset:10240
    s_waitcnt lgkmcnt(12)
    v_mfma_f32_32x32x16_bf16 v[112:127], v[220:223], v[176:179], v[112:127]
    ds_read_b64_tr_b16 v[216:217], v22 offset:8192
    ds_read_b64_tr_b16 v[218:219], v22 offset:10240
    s_waitcnt lgkmcnt(12)
    v_mfma_f32_32x32x16_bf16 v[64:79], v[224:227], v[180:183], v[64:79]
    ds_read_b64_tr_b16 v[220:221], v23 offset:8192
    ds_read_b64_tr_b16 v[222:223], v23 offset:10240
    s_waitcnt lgkmcnt(12)
    v_mfma_f32_32x32x16_bf16 v[80:95], v[228:231], v[180:183], v[80:95]
    ds_read_b64_tr_b16 v[224:225], v20 offset:12288
    ds_read_b64_tr_b16 v[226:227], v20 offset:14336
    s_waitcnt lgkmcnt(12)
    v_mfma_f32_32x32x16_bf16 v[96:111], v[232:235], v[180:183], v[96:111]
    ds_read_b64_tr_b16 v[228:229], v21 offset:12288
    ds_read_b64_tr_b16 v[230:231], v21 offset:14336
    s_waitcnt lgkmcnt(12)
    v_mfma_f32_32x32x16_bf16 v[112:127], v[236:239], v[180:183], v[112:127]
    ds_read_b64_tr_b16 v[232:233], v22 offset:12288
    ds_read_b64_tr_b16 v[234:235], v22 offset:14336
    s_waitcnt lgkmcnt(12)
    v_mfma_f32_32x32x16_bf16 v[64:79], v[208:211], v[184:187], v[64:79]
    ds_read_b64_tr_b16 v[236:237], v23 offset:12288
    ds_read_b64_tr_b16 v[238:239], v23 offset:14336
    s_waitcnt lgkmcnt(12)
    v_mfma_f32_32x32x16_bf16 v[80:95], v[212:215], v[184:187], v[80:95]
    v_add_u32 v16, 0, v14
    v_xor_b32 v17, 64, v16
    v_xor_b32 v18, 128, v16
    v_xor_b32 v19, 192, v16
    ds_read_b64_tr_b16 v[208:209], v16 offset:0
    ds_read_b64_tr_b16 v[210:211], v16 offset:2048
    s_waitcnt lgkmcnt(12)
    v_mfma_f32_32x32x16_bf16 v[96:111], v[216:219], v[184:187], v[96:111]
    ds_read_b64_tr_b16 v[212:213], v17 offset:0
    ds_read_b64_tr_b16 v[214:215], v17 offset:2048
    s_waitcnt lgkmcnt(12)
    v_mfma_f32_32x32x16_bf16 v[112:127], v[220:223], v[184:187], v[112:127]
    ds_read_b64_tr_b16 v[216:217], v18 offset:0
    ds_read_b64_tr_b16 v[218:219], v18 offset:2048
    s_waitcnt lgkmcnt(12)
    v_mfma_f32_32x32x16_bf16 v[64:79], v[224:227], v[188:191], v[64:79]
    ds_read_b64_tr_b16 v[220:221], v19 offset:0
    ds_read_b64_tr_b16 v[222:223], v19 offset:2048
    s_waitcnt lgkmcnt(12)
    v_mfma_f32_32x32x16_bf16 v[80:95], v[228:231], v[188:191], v[80:95]
    ds_read_b64_tr_b16 v[224:225], v16 offset:4096
    ds_read_b64_tr_b16 v[226:227], v16 offset:6144
    s_waitcnt lgkmcnt(12)
    v_mfma_f32_32x32x16_bf16 v[96:111], v[232:235], v[188:191], v[96:111]
    ds_read_b64_tr_b16 v[228:229], v17 offset:4096
    ds_read_b64_tr_b16 v[230:231], v17 offset:6144
    s_waitcnt lgkmcnt(12)
    v_mfma_f32_32x32x16_bf16 v[112:127], v[236:239], v[188:191], v[112:127]
    ds_read_b64_tr_b16 v[232:233], v18 offset:4096
    ds_read_b64_tr_b16 v[234:235], v18 offset:6144
    s_waitcnt vmcnt(20)
    s_waitcnt lgkmcnt(12)
    v_mfma_f32_32x32x16_bf16 v[64:79], v[208:211], v[32:35], v[64:79]
    ds_read_b64_tr_b16 v[236:237], v19 offset:4096
    ds_read_b64_tr_b16 v[238:239], v19 offset:6144
    s_waitcnt lgkmcnt(12)
    v_mfma_f32_32x32x16_bf16 v[80:95], v[212:215], v[32:35], v[80:95]
    ds_read_b64_tr_b16 v[208:209], v16 offset:8192
    ds_read_b64_tr_b16 v[210:211], v16 offset:10240
    s_waitcnt lgkmcnt(12)
    v_mfma_f32_32x32x16_bf16 v[96:111], v[216:219], v[32:35], v[96:111]
    ds_read_b64_tr_b16 v[212:213], v17 offset:8192
    ds_read_b64_tr_b16 v[214:215], v17 offset:10240
    s_waitcnt lgkmcnt(12)
    v_mfma_f32_32x32x16_bf16 v[112:127], v[220:223], v[32:35], v[112:127]
    ds_read_b64_tr_b16 v[216:217], v18 offset:8192
    ds_read_b64_tr_b16 v[218:219], v18 offset:10240
    s_waitcnt lgkmcnt(12)
    v_mfma_f32_32x32x16_bf16 v[64:79], v[224:227], v[36:39], v[64:79]
    ds_read_b64_tr_b16 v[220:221], v19 offset:8192
    ds_read_b64_tr_b16 v[222:223], v19 offset:10240
    s_waitcnt lgkmcnt(12)
    v_mfma_f32_32x32x16_bf16 v[80:95], v[228:231], v[36:39], v[80:95]
    ds_read_b64_tr_b16 v[224:225], v16 offset:12288
    ds_read_b64_tr_b16 v[226:227], v16 offset:14336
    s_waitcnt lgkmcnt(12)
    v_mfma_f32_32x32x16_bf16 v[96:111], v[232:235], v[36:39], v[96:111]
    ds_read_b64_tr_b16 v[228:229], v17 offset:12288
    ds_read_b64_tr_b16 v[230:231], v17 offset:14336
    s_waitcnt lgkmcnt(12)
    v_mfma_f32_32x32x16_bf16 v[112:127], v[236:239], v[36:39], v[112:127]
    ds_read_b64_tr_b16 v[232:233], v18 offset:12288
    ds_read_b64_tr_b16 v[234:235], v18 offset:14336
    s_waitcnt lgkmcnt(12)
    v_mfma_f32_32x32x16_bf16 v[64:79], v[208:211], v[40:43], v[64:79]
    ds_read_b64_tr_b16 v[236:237], v19 offset:12288
    ds_read_b64_tr_b16 v[238:239], v19 offset:14336
    s_waitcnt lgkmcnt(12)
    v_mfma_f32_32x32x16_bf16 v[80:95], v[212:215], v[40:43], v[80:95]
    v_add_u32 v20, 32768, v14
    v_xor_b32 v21, 64, v20
    v_xor_b32 v22, 128, v20
    v_xor_b32 v23, 192, v20
    ds_read_b64_tr_b16 v[208:209], v20 offset:0
    ds_read_b64_tr_b16 v[210:211], v20 offset:2048
    s_waitcnt lgkmcnt(12)
    v_mfma_f32_32x32x16_bf16 v[96:111], v[216:219], v[40:43], v[96:111]
    ds_read_b64_tr_b16 v[212:213], v21 offset:0
    ds_read_b64_tr_b16 v[214:215], v21 offset:2048
    s_waitcnt lgkmcnt(12)
    v_mfma_f32_32x32x16_bf16 v[112:127], v[220:223], v[40:43], v[112:127]
    ds_read_b64_tr_b16 v[216:217], v22 offset:0
    ds_read_b64_tr_b16 v[218:219], v22 offset:2048
    s_waitcnt lgkmcnt(12)
    v_mfma_f32_32x32x16_bf16 v[64:79], v[224:227], v[44:47], v[64:79]
    ds_read_b64_tr_b16 v[220:221], v23 offset:0
    ds_read_b64_tr_b16 v[222:223], v23 offset:2048
    s_waitcnt lgkmcnt(12)
    v_mfma_f32_32x32x16_bf16 v[80:95], v[228:231], v[44:47], v[80:95]
    ds_read_b64_tr_b16 v[224:225], v20 offset:4096
    ds_read_b64_tr_b16 v[226:227], v20 offset:6144
    s_waitcnt lgkmcnt(12)
    v_mfma_f32_32x32x16_bf16 v[96:111], v[232:235], v[44:47], v[96:111]
    ds_read_b64_tr_b16 v[228:229], v21 offset:4096
    ds_read_b64_tr_b16 v[230:231], v21 offset:6144
    s_waitcnt lgkmcnt(12)
    v_mfma_f32_32x32x16_bf16 v[112:127], v[236:239], v[44:47], v[112:127]
    ds_read_b64_tr_b16 v[232:233], v22 offset:4096
    ds_read_b64_tr_b16 v[234:235], v22 offset:6144
    s_waitcnt vmcnt(16)
    s_waitcnt lgkmcnt(12)
    v_mfma_f32_32x32x16_bf16 v[64:79], v[208:211], v[48:51], v[64:79]
    ds_read_b64_tr_b16 v[236:237], v23 offset:4096
    ds_read_b64_tr_b16 v[238:239], v23 offset:6144
    s_waitcnt lgkmcnt(12)
    v_mfma_f32_32x32x16_bf16 v[80:95], v[212:215], v[48:51], v[80:95]
    ds_read_b64_tr_b16 v[208:209], v20 offset:8192
    ds_read_b64_tr_b16 v[210:211], v20 offset:10240
    s_waitcnt lgkmcnt(12)
    v_mfma_f32_32x32x16_bf16 v[96:111], v[216:219], v[48:51], v[96:111]
    ds_read_b64_tr_b16 v[212:213], v21 offset:8192
    ds_read_b64_tr_b16 v[214:215], v21 offset:10240
    s_waitcnt lgkmcnt(12)
    v_mfma_f32_32x32x16_bf16 v[112:127], v[220:223], v[48:51], v[112:127]
    ds_read_b64_tr_b16 v[216:217], v22 offset:8192
    ds_read_b64_tr_b16 v[218:219], v22 offset:10240
    s_waitcnt lgkmcnt(12)
    v_mfma_f32_32x32x16_bf16 v[64:79], v[224:227], v[52:55], v[64:79]
    ds_read_b64_tr_b16 v[220:221], v23 offset:8192
    ds_read_b64_tr_b16 v[222:223], v23 offset:10240
    s_waitcnt lgkmcnt(12)
    v_mfma_f32_32x32x16_bf16 v[80:95], v[228:231], v[52:55], v[80:95]
    ds_read_b64_tr_b16 v[224:225], v20 offset:12288
    ds_read_b64_tr_b16 v[226:227], v20 offset:14336
    s_waitcnt lgkmcnt(12)
    v_mfma_f32_32x32x16_bf16 v[96:111], v[232:235], v[52:55], v[96:111]
    ds_read_b64_tr_b16 v[228:229], v21 offset:12288
    ds_read_b64_tr_b16 v[230:231], v21 offset:14336
    s_waitcnt lgkmcnt(12)
    v_mfma_f32_32x32x16_bf16 v[112:127], v[236:239], v[52:55], v[112:127]
    ds_read_b64_tr_b16 v[232:233], v22 offset:12288
    ds_read_b64_tr_b16 v[234:235], v22 offset:14336
    s_waitcnt lgkmcnt(12)
    v_mfma_f32_32x32x16_bf16 v[64:79], v[208:211], v[56:59], v[64:79]
    ds_read_b64_tr_b16 v[236:237], v23 offset:12288
    ds_read_b64_tr_b16 v[238:239], v23 offset:14336
    s_waitcnt lgkmcnt(12)
    v_mfma_f32_32x32x16_bf16 v[80:95], v[212:215], v[56:59], v[80:95]
    s_waitcnt vmcnt(0)
    s_barrier
    v_add_u32 v16, 65536, v14
    v_xor_b32 v17, 64, v16
    v_xor_b32 v18, 128, v16
    v_xor_b32 v19, 192, v16
    ds_read_b64_tr_b16 v[208:209], v16 offset:0
    ds_read_b64_tr_b16 v[210:211], v16 offset:2048
    s_waitcnt lgkmcnt(12)
    v_mfma_f32_32x32x16_bf16 v[96:111], v[216:219], v[56:59], v[96:111]
    ds_read_b64_tr_b16 v[212:213], v17 offset:0
    ds_read_b64_tr_b16 v[214:215], v17 offset:2048
    s_waitcnt lgkmcnt(12)
    v_mfma_f32_32x32x16_bf16 v[112:127], v[220:223], v[56:59], v[112:127]
    ds_read_b64_tr_b16 v[216:217], v18 offset:0
    ds_read_b64_tr_b16 v[218:219], v18 offset:2048
    s_waitcnt lgkmcnt(12)
    v_mfma_f32_32x32x16_bf16 v[64:79], v[224:227], v[60:63], v[64:79]
    ds_read_b64_tr_b16 v[220:221], v19 offset:0
    ds_read_b64_tr_b16 v[222:223], v19 offset:2048
    s_waitcnt lgkmcnt(12)
    v_mfma_f32_32x32x16_bf16 v[80:95], v[228:231], v[60:63], v[80:95]
    ds_read_b64_tr_b16 v[224:225], v16 offset:4096
    ds_read_b64_tr_b16 v[226:227], v16 offset:6144
    s_waitcnt lgkmcnt(12)
    v_mfma_f32_32x32x16_bf16 v[96:111], v[232:235], v[60:63], v[96:111]
    ds_read_b64_tr_b16 v[228:229], v17 offset:4096
    ds_read_b64_tr_b16 v[230:231], v17 offset:6144
    s_waitcnt lgkmcnt(12)
    v_mfma_f32_32x32x16_bf16 v[112:127], v[236:239], v[60:63], v[112:127]
    ds_read_b64_tr_b16 v[232:233], v18 offset:4096
    ds_read_b64_tr_b16 v[234:235], v18 offset:6144
    s_waitcnt lgkmcnt(12)
    v_mfma_f32_32x32x16_bf16 v[64:79], v[208:211], v[128:131], v[64:79]
    ds_read_b64_tr_b16 v[236:237], v19 offset:4096
    ds_read_b64_tr_b16 v[238:239], v19 offset:6144
    s_waitcnt lgkmcnt(12)
    v_mfma_f32_32x32x16_bf16 v[80:95], v[212:215], v[128:131], v[80:95]
    ds_read_b64_tr_b16 v[208:209], v16 offset:8192
    ds_read_b64_tr_b16 v[210:211], v16 offset:10240
    s_waitcnt lgkmcnt(12)
    v_mfma_f32_32x32x16_bf16 v[96:111], v[216:219], v[128:131], v[96:111]
    ds_read_b64_tr_b16 v[212:213], v17 offset:8192
    ds_read_b64_tr_b16 v[214:215], v17 offset:10240
    s_waitcnt lgkmcnt(12)
    v_mfma_f32_32x32x16_bf16 v[112:127], v[220:223], v[128:131], v[112:127]
    ds_read_b64_tr_b16 v[216:217], v18 offset:8192
    ds_read_b64_tr_b16 v[218:219], v18 offset:10240
    s_waitcnt lgkmcnt(12)
    v_mfma_f32_32x32x16_bf16 v[64:79], v[224:227], v[132:135], v[64:79]
    ds_read_b64_tr_b16 v[220:221], v19 offset:8192
    ds_read_b64_tr_b16 v[222:223], v19 offset:10240
    s_waitcnt lgkmcnt(12)
    v_mfma_f32_32x32x16_bf16 v[80:95], v[228:231], v[132:135], v[80:95]
    ds_read_b64_tr_b16 v[224:225], v16 offset:12288
    ds_read_b64_tr_b16 v[226:227], v16 offset:14336
    s_waitcnt lgkmcnt(12)
    v_mfma_f32_32x32x16_bf16 v[96:111], v[232:235], v[132:135], v[96:111]
    ds_read_b64_tr_b16 v[228:229], v17 offset:12288
    ds_read_b64_tr_b16 v[230:231], v17 offset:14336
    s_waitcnt lgkmcnt(12)
    v_mfma_f32_32x32x16_bf16 v[112:127], v[236:239], v[132:135], v[112:127]
    ds_read_b64_tr_b16 v[232:233], v18 offset:12288
    ds_read_b64_tr_b16 v[234:235], v18 offset:14336
    s_waitcnt lgkmcnt(12)
    v_mfma_f32_32x32x16_bf16 v[64:79], v[208:211], v[136:139], v[64:79]
    ds_read_b64_tr_b16 v[236:237], v19 offset:12288
    ds_read_b64_tr_b16 v[238:239], v19 offset:14336
    s_waitcnt lgkmcnt(12)
    v_mfma_f32_32x32x16_bf16 v[80:95], v[212:215], v[136:139], v[80:95]
    v_add_u32 v20, 98304, v14
    v_xor_b32 v21, 64, v20
    v_xor_b32 v22, 128, v20
    v_xor_b32 v23, 192, v20
    ds_read_b64_tr_b16 v[208:209], v20 offset:0
    ds_read_b64_tr_b16 v[210:211], v20 offset:2048
    s_waitcnt lgkmcnt(12)
    v_mfma_f32_32x32x16_bf16 v[96:111], v[216:219], v[136:139], v[96:111]
    ds_read_b64_tr_b16 v[212:213], v21 offset:0
    ds_read_b64_tr_b16 v[214:215], v21 offset:2048
    s_waitcnt lgkmcnt(12)
    v_mfma_f32_32x32x16_bf16 v[112:127], v[220:223], v[136:139], v[112:127]
    ds_read_b64_tr_b16 v[216:217], v22 offset:0
    ds_read_b64_tr_b16 v[218:219], v22 offset:2048
    s_waitcnt lgkmcnt(12)
    v_mfma_f32_32x32x16_bf16 v[64:79], v[224:227], v[140:143], v[64:79]
    ds_read_b64_tr_b16 v[220:221], v23 offset:0
    ds_read_b64_tr_b16 v[222:223], v23 offset:2048
    s_waitcnt lgkmcnt(12)
    v_mfma_f32_32x32x16_bf16 v[80:95], v[228:231], v[140:143], v[80:95]
    ds_read_b64_tr_b16 v[224:225], v20 offset:4096
    ds_read_b64_tr_b16 v[226:227], v20 offset:6144
    s_waitcnt lgkmcnt(12)
    v_mfma_f32_32x32x16_bf16 v[96:111], v[232:235], v[140:143], v[96:111]
    ds_read_b64_tr_b16 v[228:229], v21 offset:4096
    ds_read_b64_tr_b16 v[230:231], v21 offset:6144
    s_waitcnt lgkmcnt(12)
    v_mfma_f32_32x32x16_bf16 v[112:127], v[236:239], v[140:143], v[112:127]
    ds_read_b64_tr_b16 v[232:233], v22 offset:4096
    ds_read_b64_tr_b16 v[234:235], v22 offset:6144
    s_waitcnt lgkmcnt(12)
    v_mfma_f32_32x32x16_bf16 v[64:79], v[208:211], v[144:147], v[64:79]
    ds_read_b64_tr_b16 v[236:237], v23 offset:4096
    ds_read_b64_tr_b16 v[238:239], v23 offset:6144
    s_waitcnt lgkmcnt(12)
    v_mfma_f32_32x32x16_bf16 v[80:95], v[212:215], v[144:147], v[80:95]
    ds_read_b64_tr_b16 v[208:209], v20 offset:8192
    ds_read_b64_tr_b16 v[210:211], v20 offset:10240
    s_waitcnt lgkmcnt(12)
    v_mfma_f32_32x32x16_bf16 v[96:111], v[216:219], v[144:147], v[96:111]
    ds_read_b64_tr_b16 v[212:213], v21 offset:8192
    ds_read_b64_tr_b16 v[214:215], v21 offset:10240
    s_waitcnt lgkmcnt(12)
    v_mfma_f32_32x32x16_bf16 v[112:127], v[220:223], v[144:147], v[112:127]
    ds_read_b64_tr_b16 v[216:217], v22 offset:8192
    ds_read_b64_tr_b16 v[218:219], v22 offset:10240
    s_waitcnt lgkmcnt(12)
    v_mfma_f32_32x32x16_bf16 v[64:79], v[224:227], v[148:151], v[64:79]
    ds_read_b64_tr_b16 v[220:221], v23 offset:8192
    ds_read_b64_tr_b16 v[222:223], v23 offset:10240
    s_waitcnt lgkmcnt(12)
    v_mfma_f32_32x32x16_bf16 v[80:95], v[228:231], v[148:151], v[80:95]
    ds_read_b64_tr_b16 v[224:225], v20 offset:12288
    ds_read_b64_tr_b16 v[226:227], v20 offset:14336
    s_waitcnt lgkmcnt(12)
    v_mfma_f32_32x32x16_bf16 v[96:111], v[232:235], v[148:151], v[96:111]
    ds_read_b64_tr_b16 v[228:229], v21 offset:12288
    ds_read_b64_tr_b16 v[230:231], v21 offset:14336
    s_waitcnt lgkmcnt(12)
    v_mfma_f32_32x32x16_bf16 v[112:127], v[236:239], v[148:151], v[112:127]
    ds_read_b64_tr_b16 v[232:233], v22 offset:12288
    ds_read_b64_tr_b16 v[234:235], v22 offset:14336
    s_waitcnt lgkmcnt(12)
    v_mfma_f32_32x32x16_bf16 v[64:79], v[208:211], v[152:155], v[64:79]
    ds_read_b64_tr_b16 v[236:237], v23 offset:12288
    ds_read_b64_tr_b16 v[238:239], v23 offset:14336
    s_waitcnt lgkmcnt(12)
    v_mfma_f32_32x32x16_bf16 v[80:95], v[212:215], v[152:155], v[80:95]
    s_waitcnt lgkmcnt(10)
    v_mfma_f32_32x32x16_bf16 v[96:111], v[216:219], v[152:155], v[96:111]
    s_waitcnt lgkmcnt(8)
    v_mfma_f32_32x32x16_bf16 v[112:127], v[220:223], v[152:155], v[112:127]
    s_waitcnt lgkmcnt(6)
    v_mfma_f32_32x32x16_bf16 v[64:79], v[224:227], v[156:159], v[64:79]
    s_waitcnt lgkmcnt(4)
    v_mfma_f32_32x32x16_bf16 v[80:95], v[228:231], v[156:159], v[80:95]
    s_waitcnt lgkmcnt(2)
    v_mfma_f32_32x32x16_bf16 v[96:111], v[232:235], v[156:159], v[96:111]
    s_waitcnt lgkmcnt(0)
    v_mfma_f32_32x32x16_bf16 v[112:127], v[236:239], v[156:159], v[112:127]
    s_lshl_b32 s65, s76, 13
    s_lshl_b32 s66, s71, 17
    s_add_u32 s66, s66, s65
    s_xor_b32 s65, s66, 0x20000
    v_add_u32 v16, s65, v31
    v_add_u32 v17, s66, v31
    s_lshl2_add_u32 s67, s30, s29
    s_lshl_b32 s67, s67, 16
    s_lshl_b32 s57, s52, 11
    s_add_u32 s67, s67, s57
    s_nop 4
    ds_write_b128 v16, v[72:75] offset:0
    ds_write_b128 v16, v[76:79] offset:1024
    ds_write_b128 v16, v[88:91] offset:2048
    ds_write_b128 v16, v[92:95] offset:3072
    ds_write_b128 v16, v[104:107] offset:4096
    ds_write_b128 v16, v[108:111] offset:5120
    ds_write_b128 v16, v[120:123] offset:6144
    ds_write_b128 v16, v[124:127] offset:7168
    s_waitcnt lgkmcnt(0)
    s_barrier
    ds_read_b128 v[216:219], v17 offset:2048
    ds_read_b128 v[220:223], v17 offset:3072
    ds_read_b128 v[224:227], v17 offset:4096
    ds_read_b128 v[228:231], v17 offset:5120
    ds_read_b128 v[232:235], v17 offset:6144
    ds_read_b128 v[236:239], v17 offset:7168
    ds_read_b128 v[208:211], v17 offset:0
    ds_read_b128 v[212:215], v17 offset:1024
    s_xor_b32 s65, s67, 278528
    s_waitcnt lgkmcnt(7)
    v_add_f32 v80, v80, v216
    v_add_f32 v81, v81, v217
    v_add_f32 v82, v82, v218
    v_add_f32 v83, v83, v219
    s_waitcnt lgkmcnt(6)
    v_add_f32 v84, v84, v220
    v_add_f32 v85, v85, v221
    v_add_f32 v86, v86, v222
    v_add_f32 v87, v87, v223
    v_cvt_pk_bf16_f32 v88, v80, v81
    v_cvt_pk_bf16_f32 v89, v82, v83
    v_cvt_pk_bf16_f32 v90, v84, v85
    v_cvt_pk_bf16_f32 v91, v86, v87
    buffer_store_dwordx4 v[88:91], v31, s[36:39], s65 offen sc1
    s_xor_b32 s65, s67, 557056
    s_waitcnt lgkmcnt(5)
    v_add_f32 v96, v96, v224
    v_add_f32 v97, v97, v225
    v_add_f32 v98, v98, v226
    v_add_f32 v99, v99, v227
    s_waitcnt lgkmcnt(4)
    v_add_f32 v100, v100, v228
    v_add_f32 v101, v101, v229
    v_add_f32 v102, v102, v230
    v_add_f32 v103, v103, v231
    v_cvt_pk_bf16_f32 v104, v96, v97
    v_cvt_pk_bf16_f32 v105, v98, v99
    v_cvt_pk_bf16_f32 v106, v100, v101
    v_cvt_pk_bf16_f32 v107, v102, v103
    buffer_store_dwordx4 v[104:107], v31, s[36:39], s65 offen sc1
    s_xor_b32 s65, s67, 835584
    s_waitcnt lgkmcnt(3)
    v_add_f32 v112, v112, v232
    v_add_f32 v113, v113, v233
    v_add_f32 v114, v114, v234
    v_add_f32 v115, v115, v235
    s_waitcnt lgkmcnt(2)
    v_add_f32 v116, v116, v236
    v_add_f32 v117, v117, v237
    v_add_f32 v118, v118, v238
    v_add_f32 v119, v119, v239
    v_cvt_pk_bf16_f32 v120, v112, v113
    v_cvt_pk_bf16_f32 v121, v114, v115
    v_cvt_pk_bf16_f32 v122, v116, v117
    v_cvt_pk_bf16_f32 v123, v118, v119
    buffer_store_dwordx4 v[120:123], v31, s[36:39], s65 offen sc1
    s_waitcnt lgkmcnt(1)
    v_add_f32 v64, v64, v208
    v_add_f32 v65, v65, v209
    v_add_f32 v66, v66, v210
    v_add_f32 v67, v67, v211
    s_waitcnt lgkmcnt(0)
    v_add_f32 v68, v68, v212
    v_add_f32 v69, v69, v213
    v_add_f32 v70, v70, v214
    v_add_f32 v71, v71, v215
    v_and_b32 v5, 31, v0
    v_lshrrev_b32 v6, 5, v0
    v_lshlrev_b32 v5, 11, v5
    v_lshl_add_u32 v5, v6, 4, v5
    s_lshl_b32 s65, s76, 16
    s_lshl2_add_u32 s66, s29, s30
    s_lshl1_add_u32 s66, s66, s71
    s_lshl_b32 s66, s66, 5
    s_add_u32 s66, s66, s65
    s_lshl_b32 s65, s29, 8
    s_waitcnt vmcnt(0)
    s_mov_b64 exec, 1
    buffer_store_dword v4, off, s[80:83], s78 offset:128 sc1
    s_mov_b64 exec, -1
    s_mov_b32 s58, 0
concat_heads__mha_block_cached__gqa_block_cached__near_ridge_kernel_p2:
    buffer_load_dword v15, v3, s[80:83], s65 offen offset:128 sc1
    s_waitcnt vmcnt(0)
concat_heads__mha_block_cached__gqa_block_cached__near_ridge_kernel_p2c:
    v_cmp_ne_u32 vcc, 1, v15
    s_add_u32 s58, s58, 1
    s_cmp_ge_u32 s58, 0x80000
    s_cbranch_scc1 concat_heads__mha_block_cached__gqa_block_cached__near_ridge_kernel_p2x
    s_cbranch_vccnz concat_heads__mha_block_cached__gqa_block_cached__near_ridge_kernel_p2
concat_heads__mha_block_cached__gqa_block_cached__near_ridge_kernel_p2x:
    s_add_u32 s67, s67, 16384
    buffer_load_dwordx4 v[216:219], v31, s[36:39], s67 offen offset:0 sc1
    s_add_u32 s67, s67, 16384
    buffer_load_dwordx4 v[224:227], v31, s[36:39], s67 offen offset:0 sc1
    s_add_u32 s67, s67, 16384
    buffer_load_dwordx4 v[232:235], v31, s[36:39], s67 offen offset:0 sc1
    s_waitcnt vmcnt(2)
    v_lshlrev_b32 v220, 16, v216
    v_and_b32 v221, 0xffff0000, v216
    v_add_f32 v64, v64, v220
    v_add_f32 v65, v65, v221
    v_lshlrev_b32 v220, 16, v217
    v_and_b32 v221, 0xffff0000, v217
    v_add_f32 v66, v66, v220
    v_add_f32 v67, v67, v221
    v_lshlrev_b32 v220, 16, v218
    v_and_b32 v221, 0xffff0000, v218
    v_add_f32 v68, v68, v220
    v_add_f32 v69, v69, v221
    v_lshlrev_b32 v220, 16, v219
    v_and_b32 v221, 0xffff0000, v219
    v_add_f32 v70, v70, v220
    v_add_f32 v71, v71, v221
    s_waitcnt vmcnt(1)
    v_lshlrev_b32 v228, 16, v224
    v_and_b32 v229, 0xffff0000, v224
    v_add_f32 v64, v64, v228
    v_add_f32 v65, v65, v229
    v_lshlrev_b32 v228, 16, v225
    v_and_b32 v229, 0xffff0000, v225
    v_add_f32 v66, v66, v228
    v_add_f32 v67, v67, v229
    v_lshlrev_b32 v228, 16, v226
    v_and_b32 v229, 0xffff0000, v226
    v_add_f32 v68, v68, v228
    v_add_f32 v69, v69, v229
    v_lshlrev_b32 v228, 16, v227
    v_and_b32 v229, 0xffff0000, v227
    v_add_f32 v70, v70, v228
    v_add_f32 v71, v71, v229
    s_waitcnt vmcnt(0)
    v_lshlrev_b32 v236, 16, v232
    v_and_b32 v237, 0xffff0000, v232
    v_add_f32 v64, v64, v236
    v_add_f32 v65, v65, v237
    v_lshlrev_b32 v236, 16, v233
    v_and_b32 v237, 0xffff0000, v233
    v_add_f32 v66, v66, v236
    v_add_f32 v67, v67, v237
    v_lshlrev_b32 v236, 16, v234
    v_and_b32 v237, 0xffff0000, v234
    v_add_f32 v68, v68, v236
    v_add_f32 v69, v69, v237
    v_lshlrev_b32 v236, 16, v235
    v_and_b32 v237, 0xffff0000, v235
    v_add_f32 v70, v70, v236
    v_add_f32 v71, v71, v237
    v_cvt_pk_bf16_f32 v208, v64, v65
    v_cvt_pk_bf16_f32 v209, v66, v67
    v_cvt_pk_bf16_f32 v210, v68, v69
    v_cvt_pk_bf16_f32 v211, v70, v71
    s_nop 1
    v_permlane32_swap_b32 v208, v210
    v_permlane32_swap_b32 v209, v211
    s_nop 1
    buffer_store_dwordx4 v[208:211], v5, s[72:75], s66 offen
    s_waitcnt vmcnt(0)
concat_heads__mha_block_cached__gqa_block_cached__near_ridge_kernel_end:
    s_endpgm
concat_heads__mha_block_cached__gqa_block_cached__near_ridge_kernel_wk:
    s_cmp_eq_u32 s55, 6
    s_cbranch_scc1 concat_heads__mha_block_cached__gqa_block_cached__near_ridge_kernel_wk1
    buffer_load_dword v50, off, s[16:19], 0 sc1
concat_heads__mha_block_cached__gqa_block_cached__near_ridge_kernel_wk1:
    s_add_u32 m0, s54, s64
    s_and_b32 s57, s68, 6
    s_lshl_b32 s57, s57, 17
    s_and_b32 s58, s68, 1
    s_lshl_b32 s58, s58, 16
    s_add_u32 s57, s57, s58
    s_add_u32 s57, s57, s79
    s_add_u32 s68, s68, 1
    buffer_load_dwordx4 v240, s[32:35], s57 offen offset:0 lds
    buffer_load_dwordx4 v241, s[32:35], s57 offen offset:1024 lds
    buffer_load_dwordx4 v242, s[32:35], s57 offen offset:2048 lds
    buffer_load_dwordx4 v243, s[32:35], s57 offen offset:3072 lds
    s_add_u32 s54, s54, 32768
    s_cmp_eq_u32 s54, 163840
    s_cselect_b32 s54, 0, s54
    s_add_u32 m0, s54, s64
    s_and_b32 s57, s68, 6
    s_lshl_b32 s57, s57, 17
    s_and_b32 s58, s68, 1
    s_lshl_b32 s58, s58, 16
    s_add_u32 s57, s57, s58
    s_add_u32 s57, s57, s79
    s_add_u32 s68, s68, 1
    buffer_load_dwordx4 v240, s[32:35], s57 offen offset:0 lds
    buffer_load_dwordx4 v241, s[32:35], s57 offen offset:1024 lds
    buffer_load_dwordx4 v242, s[32:35], s57 offen offset:2048 lds
    buffer_load_dwordx4 v243, s[32:35], s57 offen offset:3072 lds
    s_branch concat_heads__mha_block_cached__gqa_block_cached__near_ridge_kernel_a1
concat_heads__mha_block_cached__gqa_block_cached__near_ridge_kernel_resc:
    v_max_f32 v26, v26, v24
    v_sub_f32 v27, v24, v26
    v_mul_f32 v27, s59, v27
    v_exp_f32 v27, v27
    v_mov_b32 v24, v26
    v_mul_f32 v30, s59, v26
    v_sub_f32 v30, 0, v30
    v_mul_f32 v25, v25, v27
    s_cmp_eq_u32 s55, 0
    s_cbranch_scc1 concat_heads__mha_block_cached__gqa_block_cached__near_ridge_kernel_a2
    v_mul_f32 v64, v64, v27
    v_mul_f32 v65, v65, v27
    v_mul_f32 v66, v66, v27
    v_mul_f32 v67, v67, v27
    v_mul_f32 v68, v68, v27
    v_mul_f32 v69, v69, v27
    v_mul_f32 v70, v70, v27
    v_mul_f32 v71, v71, v27
    v_mul_f32 v72, v72, v27
    v_mul_f32 v73, v73, v27
    v_mul_f32 v74, v74, v27
    v_mul_f32 v75, v75, v27
    v_mul_f32 v76, v76, v27
    v_mul_f32 v77, v77, v27
    v_mul_f32 v78, v78, v27
    v_mul_f32 v79, v79, v27
    v_mul_f32 v80, v80, v27
    v_mul_f32 v81, v81, v27
    v_mul_f32 v82, v82, v27
    v_mul_f32 v83, v83, v27
    v_mul_f32 v84, v84, v27
    v_mul_f32 v85, v85, v27
    v_mul_f32 v86, v86, v27
    v_mul_f32 v87, v87, v27
    v_mul_f32 v88, v88, v27
    v_mul_f32 v89, v89, v27
    v_mul_f32 v90, v90, v27
    v_mul_f32 v91, v91, v27
    v_mul_f32 v92, v92, v27
    v_mul_f32 v93, v93, v27
    v_mul_f32 v94, v94, v27
    v_mul_f32 v95, v95, v27
    v_mul_f32 v96, v96, v27
    v_mul_f32 v97, v97, v27
    v_mul_f32 v98, v98, v27
    v_mul_f32 v99, v99, v27
    v_mul_f32 v100, v100, v27
    v_mul_f32 v101, v101, v27
    v_mul_f32 v102, v102, v27
    v_mul_f32 v103, v103, v27
    v_mul_f32 v104, v104, v27
    v_mul_f32 v105, v105, v27
    v_mul_f32 v106, v106, v27
    v_mul_f32 v107, v107, v27
    v_mul_f32 v108, v108, v27
    v_mul_f32 v109, v109, v27
    v_mul_f32 v110, v110, v27
    v_mul_f32 v111, v111, v27
    v_mul_f32 v112, v112, v27
    v_mul_f32 v113, v113, v27
    v_mul_f32 v114, v114, v27
    v_mul_f32 v115, v115, v27
    v_mul_f32 v116, v116, v27
    v_mul_f32 v117, v117, v27
    v_mul_f32 v118, v118, v27
    v_mul_f32 v119, v119, v27
    v_mul_f32 v120, v120, v27
    v_mul_f32 v121, v121, v27
    v_mul_f32 v122, v122, v27
    v_mul_f32 v123, v123, v27
    v_mul_f32 v124, v124, v27
    v_mul_f32 v125, v125, v27
    v_mul_f32 v126, v126, v27
    v_mul_f32 v127, v127, v27
    s_branch concat_heads__mha_block_cached__gqa_block_cached__near_ridge_kernel_a2
.section .rodata,"a"
.p2align 6
.amdhsa_kernel concat_heads__mha_block_cached__gqa_block_cached__near_ridge_kernel
  .amdhsa_next_free_vgpr 244
  .amdhsa_next_free_sgpr 100
  .amdhsa_accum_offset 244
  .amdhsa_group_segment_fixed_size 0
  .amdhsa_kernarg_size 104
  .amdhsa_user_sgpr_count 2
  .amdhsa_user_sgpr_kernarg_segment_ptr 1
  .amdhsa_system_sgpr_workgroup_id_x 1
.end_amdhsa_kernel
```
